```python
import torch

def _softmax(x, axis=-1):
    return torch.softmax(x, dim=axis)
def _gelu(x):
    return torch.nn.functional.gelu(x, approximate="tanh")
def _silu(x):
    return torch.nn.functional.silu(x)
def _sigmoid(x):
    return torch.sigmoid(x)
def _layernorm(x, axis=-1, eps=1e-5):
    m = x.mean(dim=axis, keepdim=True)
    v = x.var(dim=axis, keepdim=True, unbiased=False)
    return (x - m) / torch.sqrt(v + eps)
def _scatter_add(tgt, idx, src, axis=0):
    return tgt.clone().index_add_(axis, idx, src)
def _segment_sum(src, seg, n):
    out = torch.zeros((n,) + src.shape[1:], dtype=src.dtype)
    return out.index_add_(0, seg, src)
def _pad(x, pw):
    flat = tuple(v for pair in reversed(pw) for v in pair)
    return torch.nn.functional.pad(x, flat)

kernel_name = 'parallel_sum__gqa_block_cached__moe_arch_mod__decode'

def setup_inputs():

    _w = (lambda a: (lambda t: t.to(torch.bfloat16) if t.is_floating_point() else t)(torch.as_tensor(a)))
    def _A_setup():
        B, Sq, D = 1, 1, 512
        Hq, Hkv, Sk, Dh = 32, 8, 65536, 128
        assert Hq % Hkv == 0, (Hq, Hkv)
        return {
            "x": _w((lambda *s: torch.randn(*s, dtype=torch.bfloat16) * 0.05)(B, Sq, D)),
            "k_cache": _w((lambda *s: torch.randn(*s, dtype=torch.bfloat16) * 3.2)(B, Hkv, Sk, Dh)),
            "v_cache": _w((lambda *s: torch.randn(*s, dtype=torch.bfloat16) * 1.6)(B, Hkv, Sk, Dh)),
            "wq": _w((lambda *s: torch.randn(*s, dtype=torch.bfloat16) * 3.2)(D, Hq * Dh) * (D ** -0.5)),
            "wo": _w((lambda *s: torch.randn(*s, dtype=torch.bfloat16) * 1.6)(Hq * Dh, D) * ((Hq * Dh) ** -0.5)),
        }
    _A_in = _A_setup()

    def _B_setup():
        B, S, D, F, C = 1, 1, 512, 1792, 1
        return {
            "x": _w((lambda *s: torch.randn(*s, dtype=torch.bfloat16) * 0.05)(B, S, D)),
            "w_r": _w((lambda *s: torch.randn(*s, dtype=torch.bfloat16) * 0.1)(D)),
            "w_gate": _w((lambda *s: torch.randn(*s, dtype=torch.bfloat16) * 0.1)(D, F)),
            "w_up": _w((lambda *s: torch.randn(*s, dtype=torch.bfloat16) * 0.1)(D, F)),
            "w_down": _w((lambda *s: torch.randn(*s, dtype=torch.bfloat16) * 0.1)(F, D)),
        }
    _B_in = _B_setup()

    return {
        "A_x": _A_in["x"],
        "A_k_cache": _A_in["k_cache"],
        "A_v_cache": _A_in["v_cache"],
        "A_wq": _A_in["wq"],
        "A_wo": _A_in["wo"],
        "B_x": _B_in["x"],
        "B_w_r": _B_in["w_r"],
        "B_w_gate": _B_in["w_gate"],
        "B_w_up": _B_in["w_up"],
        "B_w_down": _B_in["w_down"],
    }

def reference(A_x, A_k_cache, A_v_cache, A_wq, A_wo, B_x, B_w_r, B_w_gate, B_w_up, B_w_down):
    def _A_ref(x, k_cache, v_cache, wq, wo):
        B, Sq, D = x.shape
        Hq, Dh = 32, 128
        Hkv = k_cache.shape[1]
        rep = Hq // Hkv
        q = (lambda x, *d: x.permute(*d))((x @ wq).reshape(B, Sq, Hq, Dh), 0, 2, 1, 3)
        k = (lambda x, n, axis: torch.repeat_interleave(x, n, dim=axis))(k_cache, rep, axis=1)
        v = (lambda x, n, axis: torch.repeat_interleave(x, n, dim=axis))(v_cache, rep, axis=1)
        scores = torch.einsum("bhqd,bhkd->bhqk", q, k) * (Dh ** -0.5)
        p = _softmax(scores, axis=-1)
        o = torch.einsum("bhqk,bhkd->bhqd", p, v)
        return (lambda x, *d: x.permute(*d))(o, 0, 2, 1, 3).reshape(B, Sq, Hq * Dh) @ wo

    def _B_ref(x, w_r, w_gate, w_up, w_down):
        B, S, D = x.shape
        C = 1
        r = x @ w_r
        idx = torch.argsort(-r, axis=-1)[:, :C]
        idx_e = (lambda x, n, axis: torch.repeat_interleave(x, n, dim=axis))(idx.reshape(B, C, 1), D, axis=2)
        x_sel = (lambda x, i, axis: torch.take_along_dim(x, i, dim=axis))(x, idx_e, axis=1)
        g = _silu(x_sel @ w_gate)
        u = x_sel @ w_up
        y = (g * u) @ w_down
        r_sel = _sigmoid((lambda x, i, axis: torch.take_along_dim(x, i, dim=axis))(r, idx, axis=1))
        y = y * r_sel.reshape(B, C, 1)
        b_off = (torch.arange(B) * S).reshape(B, 1)
        flat_idx = (idx + b_off).reshape(B * C)
        zero = (x * 0.0).reshape(B * S, D)
        upd = _scatter_add(zero, flat_idx, y.reshape(B * C, D), axis=0)
        return x + upd.reshape(B, S, D)

    x = A_x
    xn = _layernorm(x, axis=-1)
    return x + _A_ref(xn, A_k_cache, A_v_cache, A_wq, A_wo) + _B_ref(xn, B_w_r, B_w_gate, B_w_up, B_w_down)
```

```asm
; @launch grid=(256,1,1) block=(384,1,1) lds=15360
.amdgcn_target "amdgcn-amd-amdhsa--gfx950"
.text
.globl parallel_sum__gqa_block_cached__moe_arch_mod__decode_kernel
.p2align 8
.type parallel_sum__gqa_block_cached__moe_arch_mod__decode_kernel,@function
parallel_sum__gqa_block_cached__moe_arch_mod__decode_kernel:
	s_cmp_ge_u32 s2, 256
	s_cbranch_scc1 L_end
	s_load_dwordx16 s[8:23], s[0:1], 0
	s_load_dwordx8 s[24:31], s[0:1], 64
	s_load_dwordx2 s[32:33], s[0:1], 96
	v_lshrrev_b32 v1, 6, v0
	v_and_b32 v0, 63, v0
	s_and_b32 s34, s2, 7
	s_lshr_b32 s35, s2, 3
	v_readfirstlane_b32 s36, v1
	s_mov_b32 s58, 0xffff0000
	s_mov_b32 s59, 0x3fb8aa3b
	s_mov_b32 s57, 40000
	s_waitcnt lgkmcnt(0)
	s_load_dword s37, s[32:33], 0
	s_mov_b32 s40, s32
	s_mov_b32 s41, s33
	s_mov_b32 s42, 0x300000
	s_mov_b32 s43, 0x00020000
	s_cmp_lt_u32 s36, 4
	s_cbranch_scc1 L_S
	s_branch L_F
L_S:
	s_lshl_b32 s66, s34, 24
	s_lshl_b32 s67, s35, 19
	s_add_u32 s66, s66, s67
	s_add_u32 s44, s10, s66
	s_addc_u32 s45, s11, 0
	s_mov_b32 s46, 0x80000
	s_mov_b32 s47, 0x00020000
	s_add_u32 s48, s12, s66
	s_addc_u32 s49, s13, 0
	s_mov_b32 s50, 0x80000
	s_mov_b32 s51, 0x00020000
	s_lshl_b32 s79, s35, 13
	v_and_b32 v1, 3, v0
	v_lshlrev_b32 v1, 10, v1
	v_bfe_u32 v2, v0, 2, 2
	v_lshlrev_b32 v2, 8, v2
	v_add_u32 v1, v1, v2
	v_lshrrev_b32 v2, 4, v0
	v_lshlrev_b32 v2, 4, v2
	v_add_u32 v1, v1, v2
	v_add_u32 v2, 0x1000, v1
	v_lshlrev_b32 v3, 4, v0
	v_add_u32 v4, 0x1000, v3
	s_lshl_b32 s76, s36, 13
	s_lshl_b32 s77, s36, 13
	s_add_u32 s77, s77, 32768
	s_lshl_b32 s78, s36, 13
	s_add_u32 s78, s78, 65536
	s_barrier
	buffer_load_dwordx4 v[64:67], v1, s[44:47], s76 offen offset:0 nt
	buffer_load_dwordx4 v[68:71], v1, s[44:47], s76 offen offset:64 nt
	buffer_load_dwordx4 v[72:75], v1, s[44:47], s76 offen offset:128 nt
	buffer_load_dwordx4 v[76:79], v1, s[44:47], s76 offen offset:192 nt
	buffer_load_dwordx4 v[80:83], v2, s[44:47], s76 offen offset:0 nt
	buffer_load_dwordx4 v[84:87], v2, s[44:47], s76 offen offset:64 nt
	buffer_load_dwordx4 v[88:91], v2, s[44:47], s76 offen offset:128 nt
	buffer_load_dwordx4 v[92:95], v2, s[44:47], s76 offen offset:192 nt
	buffer_load_dwordx4 v[96:99], v3, s[48:51], s76 offen offset:0 nt
	buffer_load_dwordx4 v[100:103], v3, s[48:51], s76 offen offset:1024 nt
	buffer_load_dwordx4 v[104:107], v3, s[48:51], s76 offen offset:2048 nt
	buffer_load_dwordx4 v[108:111], v3, s[48:51], s76 offen offset:3072 nt
	buffer_load_dwordx4 v[112:115], v4, s[48:51], s76 offen offset:0 nt
	buffer_load_dwordx4 v[116:119], v4, s[48:51], s76 offen offset:1024 nt
	buffer_load_dwordx4 v[120:123], v4, s[48:51], s76 offen offset:2048 nt
	buffer_load_dwordx4 v[124:127], v4, s[48:51], s76 offen offset:3072 nt
	buffer_load_dwordx4 v[128:131], v1, s[44:47], s77 offen offset:0 nt
	buffer_load_dwordx4 v[132:135], v1, s[44:47], s77 offen offset:64 nt
	buffer_load_dwordx4 v[136:139], v1, s[44:47], s77 offen offset:128 nt
	buffer_load_dwordx4 v[140:143], v1, s[44:47], s77 offen offset:192 nt
	buffer_load_dwordx4 v[144:147], v2, s[44:47], s77 offen offset:0 nt
	buffer_load_dwordx4 v[148:151], v2, s[44:47], s77 offen offset:64 nt
	buffer_load_dwordx4 v[152:155], v2, s[44:47], s77 offen offset:128 nt
	buffer_load_dwordx4 v[156:159], v2, s[44:47], s77 offen offset:192 nt
	buffer_load_dwordx4 v[160:163], v3, s[48:51], s77 offen offset:0 nt
	buffer_load_dwordx4 v[164:167], v3, s[48:51], s77 offen offset:1024 nt
	buffer_load_dwordx4 v[168:171], v3, s[48:51], s77 offen offset:2048 nt
	buffer_load_dwordx4 v[172:175], v3, s[48:51], s77 offen offset:3072 nt
	buffer_load_dwordx4 v[176:179], v4, s[48:51], s77 offen offset:0 nt
	buffer_load_dwordx4 v[180:183], v4, s[48:51], s77 offen offset:1024 nt
	buffer_load_dwordx4 v[184:187], v4, s[48:51], s77 offen offset:2048 nt
	buffer_load_dwordx4 v[188:191], v4, s[48:51], s77 offen offset:3072 nt
	buffer_load_dwordx4 v[192:195], v1, s[44:47], s78 offen offset:0 nt
	buffer_load_dwordx4 v[196:199], v1, s[44:47], s78 offen offset:64 nt
	buffer_load_dwordx4 v[200:203], v1, s[44:47], s78 offen offset:128 nt
	buffer_load_dwordx4 v[204:207], v1, s[44:47], s78 offen offset:192 nt
	buffer_load_dwordx4 v[208:211], v2, s[44:47], s78 offen offset:0 nt
	buffer_load_dwordx4 v[212:215], v2, s[44:47], s78 offen offset:64 nt
	buffer_load_dwordx4 v[216:219], v2, s[44:47], s78 offen offset:128 nt
	buffer_load_dwordx4 v[220:223], v2, s[44:47], s78 offen offset:192 nt
	buffer_load_dwordx4 v[224:227], v3, s[48:51], s78 offen offset:0 nt
	buffer_load_dwordx4 v[228:231], v3, s[48:51], s78 offen offset:1024 nt
	buffer_load_dwordx4 v[232:235], v3, s[48:51], s78 offen offset:2048 nt
	buffer_load_dwordx4 v[236:239], v3, s[48:51], s78 offen offset:3072 nt
	buffer_load_dwordx4 v[240:243], v4, s[48:51], s78 offen offset:0 nt
	buffer_load_dwordx4 v[244:247], v4, s[48:51], s78 offen offset:1024 nt
	buffer_load_dwordx4 v[248:251], v4, s[48:51], s78 offen offset:2048 nt
	buffer_load_dwordx4 v[252:255], v4, s[48:51], s78 offen offset:3072 nt
	v_and_b32 v28, 3, v0
	v_mov_b32 v5, 0
	v_mov_b32 v7, 0
	v_mov_b32 v29, 0xffff
	v_mov_b32 v30, s58
	v_cmp_eq_u32 vcc, 0, v28
	s_nop 1
	v_cndmask_b32 v5, v5, v29, vcc
	v_cmp_eq_u32 vcc, 1, v28
	s_nop 1
	v_cndmask_b32 v5, v5, v30, vcc
	v_cmp_eq_u32 vcc, 2, v28
	s_nop 1
	v_cndmask_b32 v7, v7, v29, vcc
	v_cmp_eq_u32 vcc, 3, v28
	s_nop 1
	v_cndmask_b32 v7, v7, v30, vcc
	v_mov_b32 v10, 0
	v_mov_b32 v11, 0
	v_mov_b32 v14, 0
	v_mov_b32 v15, 0
	v_mov_b32 v18, 0
	v_mov_b32 v19, 0
	v_mov_b32 v22, 0
	v_mov_b32 v23, 0
	v_mov_b32 v26, 0
	v_mov_b32 v27, 0
	v_mov_b32 v40, 0
	v_mov_b32 v41, 0
	v_mov_b32 v42, 0
	v_mov_b32 v43, 0
	v_mov_b32 v44, 0
	v_mov_b32 v45, 0
	v_mov_b32 v46, 0
	v_mov_b32 v47, 0
	v_mov_b32 v6, 0xff800000
	v_mov_b32 v8, 0xff800000
	v_mov_b32 v9, 0
	s_mov_b32 s60, 0x3db504f3
	s_mov_b32 s61, 0x3db504f3
	v_bfe_u32 v28, v0, 2, 2
	v_lshlrev_b32 v28, 8, v28
	v_lshrrev_b32 v29, 4, v0
	v_lshlrev_b32 v29, 4, v29
	v_add_u32 v28, v28, v29
	s_lshl_b32 s66, s34, 5
	s_add_u32 s66, s66, s35
	s_lshl_b32 s66, s66, 12
	s_lshl_b32 s67, s36, 10
	s_add_u32 s67, s66, s67
	s_add_u32 s67, s67, 1048576
	s_lshl_b32 s68, s34, 2
	s_add_u32 s68, s68, s36
	s_lshl_b32 s68, s68, 5
	s_add_u32 s68, s68, s35
	s_lshl_b32 s68, s68, 4
	s_add_u32 s68, s68, 32768
	s_lshr_b32 s74, s35, 3
	s_bfe_u32 s75, s35, 0x10002
	s_lshl_b32 s66, s34, 5
	s_lshl_b32 s69, s36, 3
	s_add_u32 s66, s66, s69
	s_lshl_b32 s66, s66, 12
	s_lshl_b32 s69, s74, 10
	s_add_u32 s66, s66, s69
	s_lshl_b32 s69, s75, 9
	s_add_u32 s66, s66, s69
	s_add_u32 s69, s66, 1048576
	s_add_u32 s70, s69, 8192
	s_add_u32 s71, s69, 16384
	s_add_u32 s72, s69, 24576
	s_lshl_b32 s73, s34, 2
	s_add_u32 s73, s73, s74
	s_lshl_b32 s73, s73, 9
	s_add_u32 s73, s73, 32768
	s_mov_b32 s74, 0
	s_waitcnt lgkmcnt(0)
	s_add_u32 s37, s37, 1
	s_barrier
	ds_read_b128 v[48:51], v28 offset:4096
	ds_read_b128 v[52:55], v28 offset:4160
	ds_read_b128 v[56:59], v28 offset:4224
	ds_read_b128 v[60:63], v28 offset:4288
	s_waitcnt lgkmcnt(0)
L_S_loop:
	s_cmp_ge_u32 s76, 0x80000
	s_cbranch_scc1 L_S_done
	s_mov_b64 exec, 1
	ds_inc_rtn_u32 v28, v10, v5 offset:14852
	s_mov_b64 exec, -1
	s_cmp_eq_u32 s74, 0
	s_cbranch_scc1 L_lad_1
	s_cmp_eq_u32 s74, 1
	s_cbranch_scc1 L_lad_2
	s_waitcnt vmcnt(8)
L_lad_2:
	s_waitcnt vmcnt(24)
L_lad_1:
	s_waitcnt vmcnt(40)
	v_mfma_f32_16x16x32_bf16 v[32:35], v[64:67], v[48:51], 0
	v_mfma_f32_16x16x32_bf16 v[36:39], v[80:83], v[48:51], 0
	v_mfma_f32_16x16x32_bf16 v[32:35], v[68:71], v[52:55], v[32:35]
	v_mfma_f32_16x16x32_bf16 v[36:39], v[84:87], v[52:55], v[36:39]
	v_mfma_f32_16x16x32_bf16 v[32:35], v[72:75], v[56:59], v[32:35]
	v_mfma_f32_16x16x32_bf16 v[36:39], v[88:91], v[56:59], v[36:39]
	v_mfma_f32_16x16x32_bf16 v[32:35], v[76:79], v[60:63], v[32:35]
	v_mfma_f32_16x16x32_bf16 v[36:39], v[92:95], v[60:63], v[36:39]
	s_waitcnt lgkmcnt(0)
	v_readfirstlane_b32 s66, v28
	s_lshl_b32 s76, s66, 13
	s_cmp_ge_u32 s76, 0x80000
	s_nop 2
	s_cbranch_scc0 L_cont_5
	s_add_u32 s74, s74, 1
	s_branch L_inv_4
L_cont_5:
	buffer_load_dwordx4 v[64:67], v1, s[44:47], s76 offen offset:0 nt
	buffer_load_dwordx4 v[68:71], v1, s[44:47], s76 offen offset:64 nt
	buffer_load_dwordx4 v[72:75], v1, s[44:47], s76 offen offset:128 nt
	buffer_load_dwordx4 v[76:79], v1, s[44:47], s76 offen offset:192 nt
	buffer_load_dwordx4 v[80:83], v2, s[44:47], s76 offen offset:0 nt
	buffer_load_dwordx4 v[84:87], v2, s[44:47], s76 offen offset:64 nt
	buffer_load_dwordx4 v[88:91], v2, s[44:47], s76 offen offset:128 nt
	buffer_load_dwordx4 v[92:95], v2, s[44:47], s76 offen offset:192 nt
L_inv_4:
	v_cvt_pk_bf16_f32 v28, v32, v33
	v_cvt_pk_bf16_f32 v29, v34, v35
	v_cvt_pk_bf16_f32 v30, v36, v37
	v_cvt_pk_bf16_f32 v31, v38, v39
	v_lshlrev_b32 v32, 16, v28
	v_and_b32 v33, s58, v28
	v_lshlrev_b32 v34, 16, v29
	v_and_b32 v35, s58, v29
	v_lshlrev_b32 v36, 16, v30
	v_and_b32 v37, s58, v30
	v_lshlrev_b32 v38, 16, v31
	v_and_b32 v39, s58, v31
	v_pk_mul_f32 v[32:33], v[32:33], s[60:61]
	v_pk_mul_f32 v[34:35], v[34:35], s[60:61]
	v_pk_mul_f32 v[36:37], v[36:37], s[60:61]
	v_pk_mul_f32 v[38:39], v[38:39], s[60:61]
	v_cvt_pk_bf16_f32 v28, v32, v33
	v_cvt_pk_bf16_f32 v29, v34, v35
	v_cvt_pk_bf16_f32 v30, v36, v37
	v_cvt_pk_bf16_f32 v31, v38, v39
	v_lshlrev_b32 v32, 16, v28
	v_and_b32 v33, s58, v28
	v_lshlrev_b32 v34, 16, v29
	v_and_b32 v35, s58, v29
	v_lshlrev_b32 v36, 16, v30
	v_and_b32 v37, s58, v30
	v_lshlrev_b32 v38, 16, v31
	v_and_b32 v39, s58, v31
	v_max3_f32 v28, v32, v33, v34
	v_max3_f32 v29, v35, v36, v37
	v_max3_f32 v28, v28, v38, v39
	v_max_f32 v28, v28, v29
	v_cmp_gt_f32 vcc, v28, v6
	s_nop 3
	s_cbranch_vccz L_skip_6
	v_mov_b32 v29, v28
	s_nop 1
	v_permlane16_swap_b32 v28, v29
	v_max_f32 v28, v28, v29
	v_mov_b32 v29, v28
	s_nop 1
	v_permlane32_swap_b32 v28, v29
	v_max_f32 v28, v28, v29
	v_max_f32 v28, v28, v6
	v_mul_f32 v29, s59, v28
	v_sub_f32 v30, v8, v29
	v_exp_f32 v30, v30
	v_mov_b32 v6, v28
	v_mov_b32 v8, v29
	v_mul_f32 v9, v9, v30
	v_mov_b32_dpp v31, v30 row_newbcast:0 row_mask:0x1 bank_mask:0xf
	s_nop 1
	v_mov_b32_dpp v31, v30 row_newbcast:4 row_mask:0x2 bank_mask:0xf
	s_nop 1
	v_mov_b32_dpp v31, v30 row_newbcast:8 row_mask:0x4 bank_mask:0xf
	s_nop 1
	v_mov_b32_dpp v31, v30 row_newbcast:12 row_mask:0x8 bank_mask:0xf
	v_mul_f32 v40, v40, v31
	v_mul_f32 v41, v41, v31
	v_mul_f32 v42, v42, v31
	v_mul_f32 v43, v43, v31
	v_mul_f32 v44, v44, v31
	v_mul_f32 v45, v45, v31
	v_mul_f32 v46, v46, v31
	v_mul_f32 v47, v47, v31
	s_nop 1
L_skip_6:
	v_fma_f32 v32, v32, s59, -v8
	v_fma_f32 v33, v33, s59, -v8
	v_fma_f32 v34, v34, s59, -v8
	v_fma_f32 v35, v35, s59, -v8
	v_fma_f32 v36, v36, s59, -v8
	v_fma_f32 v37, v37, s59, -v8
	v_fma_f32 v38, v38, s59, -v8
	v_fma_f32 v39, v39, s59, -v8
	v_exp_f32 v32, v32
	v_exp_f32 v33, v33
	v_exp_f32 v34, v34
	v_exp_f32 v35, v35
	v_exp_f32 v36, v36
	v_exp_f32 v37, v37
	v_exp_f32 v38, v38
	v_exp_f32 v39, v39
	v_cvt_pk_bf16_f32 v28, v32, v32
	v_cvt_pk_bf16_f32 v29, v33, v33
	v_cvt_pk_bf16_f32 v30, v34, v34
	v_cvt_pk_bf16_f32 v31, v35, v35
	v_and_b32 v12, v28, v5
	v_and_b32 v13, v28, v7
	v_and_b32 v16, v29, v5
	v_and_b32 v17, v29, v7
	v_and_b32 v20, v30, v5
	v_and_b32 v21, v30, v7
	v_and_b32 v24, v31, v5
	v_and_b32 v25, v31, v7
	s_cmp_eq_u32 s74, 0
	s_cbranch_scc1 L_lad_7
	s_cmp_eq_u32 s74, 1
	s_cbranch_scc1 L_lad_8
	s_cmp_eq_u32 s74, 2
	s_cbranch_scc1 L_lad_9
	s_waitcnt vmcnt(0)
L_lad_9:
	s_waitcnt vmcnt(16)
L_lad_8:
	s_waitcnt vmcnt(32)
L_lad_7:
	s_waitcnt vmcnt(40)
	v_mfma_f32_16x16x32_bf16 v[40:43], v[12:15], v[96:99], v[40:43]
	v_mfma_f32_16x16x32_bf16 v[44:47], v[10:13], v[96:99], v[44:47]
	v_mfma_f32_16x16x32_bf16 v[40:43], v[16:19], v[100:103], v[40:43]
	v_mfma_f32_16x16x32_bf16 v[44:47], v[14:17], v[100:103], v[44:47]
	v_mfma_f32_16x16x32_bf16 v[40:43], v[20:23], v[104:107], v[40:43]
	v_mfma_f32_16x16x32_bf16 v[44:47], v[18:21], v[104:107], v[44:47]
	v_mfma_f32_16x16x32_bf16 v[40:43], v[24:27], v[108:111], v[40:43]
	v_mfma_f32_16x16x32_bf16 v[44:47], v[22:25], v[108:111], v[44:47]
	v_cvt_pk_bf16_f32 v28, v36, v36
	v_cvt_pk_bf16_f32 v29, v37, v37
	v_cvt_pk_bf16_f32 v30, v38, v38
	v_cvt_pk_bf16_f32 v31, v39, v39
	v_and_b32 v12, v28, v5
	v_and_b32 v13, v28, v7
	v_and_b32 v16, v29, v5
	v_and_b32 v17, v29, v7
	v_and_b32 v20, v30, v5
	v_and_b32 v21, v30, v7
	v_and_b32 v24, v31, v5
	v_and_b32 v25, v31, v7
	v_mfma_f32_16x16x32_bf16 v[40:43], v[12:15], v[112:115], v[40:43]
	v_mfma_f32_16x16x32_bf16 v[44:47], v[10:13], v[112:115], v[44:47]
	v_mfma_f32_16x16x32_bf16 v[40:43], v[16:19], v[116:119], v[40:43]
	v_mfma_f32_16x16x32_bf16 v[44:47], v[14:17], v[116:119], v[44:47]
	v_mfma_f32_16x16x32_bf16 v[40:43], v[20:23], v[120:123], v[40:43]
	v_mfma_f32_16x16x32_bf16 v[44:47], v[18:21], v[120:123], v[44:47]
	v_mfma_f32_16x16x32_bf16 v[40:43], v[24:27], v[124:127], v[40:43]
	v_mfma_f32_16x16x32_bf16 v[44:47], v[22:25], v[124:127], v[44:47]
	s_cmp_lg_u32 s74, 0
	s_nop 5
	s_cbranch_scc1 L_skv_11
	buffer_load_dwordx4 v[96:99], v3, s[48:51], s76 offen offset:0 nt
	buffer_load_dwordx4 v[100:103], v3, s[48:51], s76 offen offset:1024 nt
	buffer_load_dwordx4 v[104:107], v3, s[48:51], s76 offen offset:2048 nt
	buffer_load_dwordx4 v[108:111], v3, s[48:51], s76 offen offset:3072 nt
	buffer_load_dwordx4 v[112:115], v4, s[48:51], s76 offen offset:0 nt
	buffer_load_dwordx4 v[116:119], v4, s[48:51], s76 offen offset:1024 nt
	buffer_load_dwordx4 v[120:123], v4, s[48:51], s76 offen offset:2048 nt
	buffer_load_dwordx4 v[124:127], v4, s[48:51], s76 offen offset:3072 nt
L_skv_11:
	v_pk_add_f32 v[28:29], v[32:33], v[34:35]
	v_pk_add_f32 v[30:31], v[36:37], v[38:39]
	v_pk_add_f32 v[28:29], v[28:29], v[30:31]
	v_add_f32 v28, v28, v29
	v_add_f32 v9, v9, v28
	s_cmp_ge_u32 s77, 0x80000
	s_cbranch_scc1 L_S_done
	s_mov_b64 exec, 1
	ds_inc_rtn_u32 v28, v10, v5 offset:14852
	s_mov_b64 exec, -1
	s_cmp_eq_u32 s74, 0
	s_cbranch_scc1 L_lad_12
	s_cmp_eq_u32 s74, 1
	s_cbranch_scc1 L_lad_13
	s_waitcnt vmcnt(8)
L_lad_13:
	s_waitcnt vmcnt(24)
L_lad_12:
	s_waitcnt vmcnt(40)
	v_mfma_f32_16x16x32_bf16 v[32:35], v[128:131], v[48:51], 0
	v_mfma_f32_16x16x32_bf16 v[36:39], v[144:147], v[48:51], 0
	v_mfma_f32_16x16x32_bf16 v[32:35], v[132:135], v[52:55], v[32:35]
	v_mfma_f32_16x16x32_bf16 v[36:39], v[148:151], v[52:55], v[36:39]
	v_mfma_f32_16x16x32_bf16 v[32:35], v[136:139], v[56:59], v[32:35]
	v_mfma_f32_16x16x32_bf16 v[36:39], v[152:155], v[56:59], v[36:39]
	v_mfma_f32_16x16x32_bf16 v[32:35], v[140:143], v[60:63], v[32:35]
	v_mfma_f32_16x16x32_bf16 v[36:39], v[156:159], v[60:63], v[36:39]
	s_waitcnt lgkmcnt(0)
	v_readfirstlane_b32 s66, v28
	s_lshl_b32 s77, s66, 13
	s_cmp_ge_u32 s77, 0x80000
	s_nop 2
	s_cbranch_scc0 L_cont_16
	s_add_u32 s74, s74, 1
	s_branch L_inv_15
L_cont_16:
	buffer_load_dwordx4 v[128:131], v1, s[44:47], s77 offen offset:0 nt
	buffer_load_dwordx4 v[132:135], v1, s[44:47], s77 offen offset:64 nt
	buffer_load_dwordx4 v[136:139], v1, s[44:47], s77 offen offset:128 nt
	buffer_load_dwordx4 v[140:143], v1, s[44:47], s77 offen offset:192 nt
	buffer_load_dwordx4 v[144:147], v2, s[44:47], s77 offen offset:0 nt
	buffer_load_dwordx4 v[148:151], v2, s[44:47], s77 offen offset:64 nt
	buffer_load_dwordx4 v[152:155], v2, s[44:47], s77 offen offset:128 nt
	buffer_load_dwordx4 v[156:159], v2, s[44:47], s77 offen offset:192 nt
L_inv_15:
	v_cvt_pk_bf16_f32 v28, v32, v33
	v_cvt_pk_bf16_f32 v29, v34, v35
	v_cvt_pk_bf16_f32 v30, v36, v37
	v_cvt_pk_bf16_f32 v31, v38, v39
	v_lshlrev_b32 v32, 16, v28
	v_and_b32 v33, s58, v28
	v_lshlrev_b32 v34, 16, v29
	v_and_b32 v35, s58, v29
	v_lshlrev_b32 v36, 16, v30
	v_and_b32 v37, s58, v30
	v_lshlrev_b32 v38, 16, v31
	v_and_b32 v39, s58, v31
	v_pk_mul_f32 v[32:33], v[32:33], s[60:61]
	v_pk_mul_f32 v[34:35], v[34:35], s[60:61]
	v_pk_mul_f32 v[36:37], v[36:37], s[60:61]
	v_pk_mul_f32 v[38:39], v[38:39], s[60:61]
	v_cvt_pk_bf16_f32 v28, v32, v33
	v_cvt_pk_bf16_f32 v29, v34, v35
	v_cvt_pk_bf16_f32 v30, v36, v37
	v_cvt_pk_bf16_f32 v31, v38, v39
	v_lshlrev_b32 v32, 16, v28
	v_and_b32 v33, s58, v28
	v_lshlrev_b32 v34, 16, v29
	v_and_b32 v35, s58, v29
	v_lshlrev_b32 v36, 16, v30
	v_and_b32 v37, s58, v30
	v_lshlrev_b32 v38, 16, v31
	v_and_b32 v39, s58, v31
	v_max3_f32 v28, v32, v33, v34
	v_max3_f32 v29, v35, v36, v37
	v_max3_f32 v28, v28, v38, v39
	v_max_f32 v28, v28, v29
	v_cmp_gt_f32 vcc, v28, v6
	s_nop 3
	s_cbranch_vccz L_skip_17
	v_mov_b32 v29, v28
	s_nop 1
	v_permlane16_swap_b32 v28, v29
	v_max_f32 v28, v28, v29
	v_mov_b32 v29, v28
	s_nop 1
	v_permlane32_swap_b32 v28, v29
	v_max_f32 v28, v28, v29
	v_max_f32 v28, v28, v6
	v_mul_f32 v29, s59, v28
	v_sub_f32 v30, v8, v29
	v_exp_f32 v30, v30
	v_mov_b32 v6, v28
	v_mov_b32 v8, v29
	v_mul_f32 v9, v9, v30
	v_mov_b32_dpp v31, v30 row_newbcast:0 row_mask:0x1 bank_mask:0xf
	s_nop 1
	v_mov_b32_dpp v31, v30 row_newbcast:4 row_mask:0x2 bank_mask:0xf
	s_nop 1
	v_mov_b32_dpp v31, v30 row_newbcast:8 row_mask:0x4 bank_mask:0xf
	s_nop 1
	v_mov_b32_dpp v31, v30 row_newbcast:12 row_mask:0x8 bank_mask:0xf
	v_mul_f32 v40, v40, v31
	v_mul_f32 v41, v41, v31
	v_mul_f32 v42, v42, v31
	v_mul_f32 v43, v43, v31
	v_mul_f32 v44, v44, v31
	v_mul_f32 v45, v45, v31
	v_mul_f32 v46, v46, v31
	v_mul_f32 v47, v47, v31
	s_nop 1
L_skip_17:
	v_fma_f32 v32, v32, s59, -v8
	v_fma_f32 v33, v33, s59, -v8
	v_fma_f32 v34, v34, s59, -v8
	v_fma_f32 v35, v35, s59, -v8
	v_fma_f32 v36, v36, s59, -v8
	v_fma_f32 v37, v37, s59, -v8
	v_fma_f32 v38, v38, s59, -v8
	v_fma_f32 v39, v39, s59, -v8
	v_exp_f32 v32, v32
	v_exp_f32 v33, v33
	v_exp_f32 v34, v34
	v_exp_f32 v35, v35
	v_exp_f32 v36, v36
	v_exp_f32 v37, v37
	v_exp_f32 v38, v38
	v_exp_f32 v39, v39
	v_cvt_pk_bf16_f32 v28, v32, v32
	v_cvt_pk_bf16_f32 v29, v33, v33
	v_cvt_pk_bf16_f32 v30, v34, v34
	v_cvt_pk_bf16_f32 v31, v35, v35
	v_and_b32 v12, v28, v5
	v_and_b32 v13, v28, v7
	v_and_b32 v16, v29, v5
	v_and_b32 v17, v29, v7
	v_and_b32 v20, v30, v5
	v_and_b32 v21, v30, v7
	v_and_b32 v24, v31, v5
	v_and_b32 v25, v31, v7
	s_cmp_eq_u32 s74, 0
	s_cbranch_scc1 L_lad_18
	s_cmp_eq_u32 s74, 1
	s_cbranch_scc1 L_lad_19
	s_cmp_eq_u32 s74, 2
	s_cbranch_scc1 L_lad_20
	s_waitcnt vmcnt(0)
L_lad_20:
	s_waitcnt vmcnt(16)
L_lad_19:
	s_waitcnt vmcnt(32)
L_lad_18:
	s_waitcnt vmcnt(40)
	v_mfma_f32_16x16x32_bf16 v[40:43], v[12:15], v[160:163], v[40:43]
	v_mfma_f32_16x16x32_bf16 v[44:47], v[10:13], v[160:163], v[44:47]
	v_mfma_f32_16x16x32_bf16 v[40:43], v[16:19], v[164:167], v[40:43]
	v_mfma_f32_16x16x32_bf16 v[44:47], v[14:17], v[164:167], v[44:47]
	v_mfma_f32_16x16x32_bf16 v[40:43], v[20:23], v[168:171], v[40:43]
	v_mfma_f32_16x16x32_bf16 v[44:47], v[18:21], v[168:171], v[44:47]
	v_mfma_f32_16x16x32_bf16 v[40:43], v[24:27], v[172:175], v[40:43]
	v_mfma_f32_16x16x32_bf16 v[44:47], v[22:25], v[172:175], v[44:47]
	v_cvt_pk_bf16_f32 v28, v36, v36
	v_cvt_pk_bf16_f32 v29, v37, v37
	v_cvt_pk_bf16_f32 v30, v38, v38
	v_cvt_pk_bf16_f32 v31, v39, v39
	v_and_b32 v12, v28, v5
	v_and_b32 v13, v28, v7
	v_and_b32 v16, v29, v5
	v_and_b32 v17, v29, v7
	v_and_b32 v20, v30, v5
	v_and_b32 v21, v30, v7
	v_and_b32 v24, v31, v5
	v_and_b32 v25, v31, v7
	v_mfma_f32_16x16x32_bf16 v[40:43], v[12:15], v[176:179], v[40:43]
	v_mfma_f32_16x16x32_bf16 v[44:47], v[10:13], v[176:179], v[44:47]
	v_mfma_f32_16x16x32_bf16 v[40:43], v[16:19], v[180:183], v[40:43]
	v_mfma_f32_16x16x32_bf16 v[44:47], v[14:17], v[180:183], v[44:47]
	v_mfma_f32_16x16x32_bf16 v[40:43], v[20:23], v[184:187], v[40:43]
	v_mfma_f32_16x16x32_bf16 v[44:47], v[18:21], v[184:187], v[44:47]
	v_mfma_f32_16x16x32_bf16 v[40:43], v[24:27], v[188:191], v[40:43]
	v_mfma_f32_16x16x32_bf16 v[44:47], v[22:25], v[188:191], v[44:47]
	s_cmp_lg_u32 s74, 0
	s_nop 5
	s_cbranch_scc1 L_skv_22
	buffer_load_dwordx4 v[160:163], v3, s[48:51], s77 offen offset:0 nt
	buffer_load_dwordx4 v[164:167], v3, s[48:51], s77 offen offset:1024 nt
	buffer_load_dwordx4 v[168:171], v3, s[48:51], s77 offen offset:2048 nt
	buffer_load_dwordx4 v[172:175], v3, s[48:51], s77 offen offset:3072 nt
	buffer_load_dwordx4 v[176:179], v4, s[48:51], s77 offen offset:0 nt
	buffer_load_dwordx4 v[180:183], v4, s[48:51], s77 offen offset:1024 nt
	buffer_load_dwordx4 v[184:187], v4, s[48:51], s77 offen offset:2048 nt
	buffer_load_dwordx4 v[188:191], v4, s[48:51], s77 offen offset:3072 nt
L_skv_22:
	v_pk_add_f32 v[28:29], v[32:33], v[34:35]
	v_pk_add_f32 v[30:31], v[36:37], v[38:39]
	v_pk_add_f32 v[28:29], v[28:29], v[30:31]
	v_add_f32 v28, v28, v29
	v_add_f32 v9, v9, v28
	s_cmp_ge_u32 s78, 0x80000
	s_cbranch_scc1 L_S_done
	s_mov_b64 exec, 1
	ds_inc_rtn_u32 v28, v10, v5 offset:14852
	s_mov_b64 exec, -1
	s_cmp_eq_u32 s74, 0
	s_cbranch_scc1 L_lad_23
	s_cmp_eq_u32 s74, 1
	s_cbranch_scc1 L_lad_24
	s_waitcnt vmcnt(8)
L_lad_24:
	s_waitcnt vmcnt(24)
L_lad_23:
	s_waitcnt vmcnt(40)
	v_mfma_f32_16x16x32_bf16 v[32:35], v[192:195], v[48:51], 0
	v_mfma_f32_16x16x32_bf16 v[36:39], v[208:211], v[48:51], 0
	v_mfma_f32_16x16x32_bf16 v[32:35], v[196:199], v[52:55], v[32:35]
	v_mfma_f32_16x16x32_bf16 v[36:39], v[212:215], v[52:55], v[36:39]
	v_mfma_f32_16x16x32_bf16 v[32:35], v[200:203], v[56:59], v[32:35]
	v_mfma_f32_16x16x32_bf16 v[36:39], v[216:219], v[56:59], v[36:39]
	v_mfma_f32_16x16x32_bf16 v[32:35], v[204:207], v[60:63], v[32:35]
	v_mfma_f32_16x16x32_bf16 v[36:39], v[220:223], v[60:63], v[36:39]
	s_waitcnt lgkmcnt(0)
	v_readfirstlane_b32 s66, v28
	s_lshl_b32 s78, s66, 13
	s_cmp_ge_u32 s78, 0x80000
	s_nop 2
	s_cbranch_scc0 L_cont_27
	s_add_u32 s74, s74, 1
	s_branch L_inv_26
L_cont_27:
	buffer_load_dwordx4 v[192:195], v1, s[44:47], s78 offen offset:0 nt
	buffer_load_dwordx4 v[196:199], v1, s[44:47], s78 offen offset:64 nt
	buffer_load_dwordx4 v[200:203], v1, s[44:47], s78 offen offset:128 nt
	buffer_load_dwordx4 v[204:207], v1, s[44:47], s78 offen offset:192 nt
	buffer_load_dwordx4 v[208:211], v2, s[44:47], s78 offen offset:0 nt
	buffer_load_dwordx4 v[212:215], v2, s[44:47], s78 offen offset:64 nt
	buffer_load_dwordx4 v[216:219], v2, s[44:47], s78 offen offset:128 nt
	buffer_load_dwordx4 v[220:223], v2, s[44:47], s78 offen offset:192 nt
L_inv_26:
	v_cvt_pk_bf16_f32 v28, v32, v33
	v_cvt_pk_bf16_f32 v29, v34, v35
	v_cvt_pk_bf16_f32 v30, v36, v37
	v_cvt_pk_bf16_f32 v31, v38, v39
	v_lshlrev_b32 v32, 16, v28
	v_and_b32 v33, s58, v28
	v_lshlrev_b32 v34, 16, v29
	v_and_b32 v35, s58, v29
	v_lshlrev_b32 v36, 16, v30
	v_and_b32 v37, s58, v30
	v_lshlrev_b32 v38, 16, v31
	v_and_b32 v39, s58, v31
	v_pk_mul_f32 v[32:33], v[32:33], s[60:61]
	v_pk_mul_f32 v[34:35], v[34:35], s[60:61]
	v_pk_mul_f32 v[36:37], v[36:37], s[60:61]
	v_pk_mul_f32 v[38:39], v[38:39], s[60:61]
	v_cvt_pk_bf16_f32 v28, v32, v33
	v_cvt_pk_bf16_f32 v29, v34, v35
	v_cvt_pk_bf16_f32 v30, v36, v37
	v_cvt_pk_bf16_f32 v31, v38, v39
	v_lshlrev_b32 v32, 16, v28
	v_and_b32 v33, s58, v28
	v_lshlrev_b32 v34, 16, v29
	v_and_b32 v35, s58, v29
	v_lshlrev_b32 v36, 16, v30
	v_and_b32 v37, s58, v30
	v_lshlrev_b32 v38, 16, v31
	v_and_b32 v39, s58, v31
	v_max3_f32 v28, v32, v33, v34
	v_max3_f32 v29, v35, v36, v37
	v_max3_f32 v28, v28, v38, v39
	v_max_f32 v28, v28, v29
	v_cmp_gt_f32 vcc, v28, v6
	s_nop 3
	s_cbranch_vccz L_skip_28
	v_mov_b32 v29, v28
	s_nop 1
	v_permlane16_swap_b32 v28, v29
	v_max_f32 v28, v28, v29
	v_mov_b32 v29, v28
	s_nop 1
	v_permlane32_swap_b32 v28, v29
	v_max_f32 v28, v28, v29
	v_max_f32 v28, v28, v6
	v_mul_f32 v29, s59, v28
	v_sub_f32 v30, v8, v29
	v_exp_f32 v30, v30
	v_mov_b32 v6, v28
	v_mov_b32 v8, v29
	v_mul_f32 v9, v9, v30
	v_mov_b32_dpp v31, v30 row_newbcast:0 row_mask:0x1 bank_mask:0xf
	s_nop 1
	v_mov_b32_dpp v31, v30 row_newbcast:4 row_mask:0x2 bank_mask:0xf
	s_nop 1
	v_mov_b32_dpp v31, v30 row_newbcast:8 row_mask:0x4 bank_mask:0xf
	s_nop 1
	v_mov_b32_dpp v31, v30 row_newbcast:12 row_mask:0x8 bank_mask:0xf
	v_mul_f32 v40, v40, v31
	v_mul_f32 v41, v41, v31
	v_mul_f32 v42, v42, v31
	v_mul_f32 v43, v43, v31
	v_mul_f32 v44, v44, v31
	v_mul_f32 v45, v45, v31
	v_mul_f32 v46, v46, v31
	v_mul_f32 v47, v47, v31
	s_nop 1
L_skip_28:
	v_fma_f32 v32, v32, s59, -v8
	v_fma_f32 v33, v33, s59, -v8
	v_fma_f32 v34, v34, s59, -v8
	v_fma_f32 v35, v35, s59, -v8
	v_fma_f32 v36, v36, s59, -v8
	v_fma_f32 v37, v37, s59, -v8
	v_fma_f32 v38, v38, s59, -v8
	v_fma_f32 v39, v39, s59, -v8
	v_exp_f32 v32, v32
	v_exp_f32 v33, v33
	v_exp_f32 v34, v34
	v_exp_f32 v35, v35
	v_exp_f32 v36, v36
	v_exp_f32 v37, v37
	v_exp_f32 v38, v38
	v_exp_f32 v39, v39
	v_cvt_pk_bf16_f32 v28, v32, v32
	v_cvt_pk_bf16_f32 v29, v33, v33
	v_cvt_pk_bf16_f32 v30, v34, v34
	v_cvt_pk_bf16_f32 v31, v35, v35
	v_and_b32 v12, v28, v5
	v_and_b32 v13, v28, v7
	v_and_b32 v16, v29, v5
	v_and_b32 v17, v29, v7
	v_and_b32 v20, v30, v5
	v_and_b32 v21, v30, v7
	v_and_b32 v24, v31, v5
	v_and_b32 v25, v31, v7
	s_cmp_eq_u32 s74, 0
	s_cbranch_scc1 L_lad_29
	s_cmp_eq_u32 s74, 1
	s_cbranch_scc1 L_lad_30
	s_cmp_eq_u32 s74, 2
	s_cbranch_scc1 L_lad_31
	s_waitcnt vmcnt(0)
L_lad_31:
	s_waitcnt vmcnt(16)
L_lad_30:
	s_waitcnt vmcnt(32)
L_lad_29:
	s_waitcnt vmcnt(40)
	v_mfma_f32_16x16x32_bf16 v[40:43], v[12:15], v[224:227], v[40:43]
	v_mfma_f32_16x16x32_bf16 v[44:47], v[10:13], v[224:227], v[44:47]
	v_mfma_f32_16x16x32_bf16 v[40:43], v[16:19], v[228:231], v[40:43]
	v_mfma_f32_16x16x32_bf16 v[44:47], v[14:17], v[228:231], v[44:47]
	v_mfma_f32_16x16x32_bf16 v[40:43], v[20:23], v[232:235], v[40:43]
	v_mfma_f32_16x16x32_bf16 v[44:47], v[18:21], v[232:235], v[44:47]
	v_mfma_f32_16x16x32_bf16 v[40:43], v[24:27], v[236:239], v[40:43]
	v_mfma_f32_16x16x32_bf16 v[44:47], v[22:25], v[236:239], v[44:47]
	v_cvt_pk_bf16_f32 v28, v36, v36
	v_cvt_pk_bf16_f32 v29, v37, v37
	v_cvt_pk_bf16_f32 v30, v38, v38
	v_cvt_pk_bf16_f32 v31, v39, v39
	v_and_b32 v12, v28, v5
	v_and_b32 v13, v28, v7
	v_and_b32 v16, v29, v5
	v_and_b32 v17, v29, v7
	v_and_b32 v20, v30, v5
	v_and_b32 v21, v30, v7
	v_and_b32 v24, v31, v5
	v_and_b32 v25, v31, v7
	v_mfma_f32_16x16x32_bf16 v[40:43], v[12:15], v[240:243], v[40:43]
	v_mfma_f32_16x16x32_bf16 v[44:47], v[10:13], v[240:243], v[44:47]
	v_mfma_f32_16x16x32_bf16 v[40:43], v[16:19], v[244:247], v[40:43]
	v_mfma_f32_16x16x32_bf16 v[44:47], v[14:17], v[244:247], v[44:47]
	v_mfma_f32_16x16x32_bf16 v[40:43], v[20:23], v[248:251], v[40:43]
	v_mfma_f32_16x16x32_bf16 v[44:47], v[18:21], v[248:251], v[44:47]
	v_mfma_f32_16x16x32_bf16 v[40:43], v[24:27], v[252:255], v[40:43]
	v_mfma_f32_16x16x32_bf16 v[44:47], v[22:25], v[252:255], v[44:47]
	s_cmp_lg_u32 s74, 0
	s_nop 5
	s_cbranch_scc1 L_skv_33
	buffer_load_dwordx4 v[224:227], v3, s[48:51], s78 offen offset:0 nt
	buffer_load_dwordx4 v[228:231], v3, s[48:51], s78 offen offset:1024 nt
	buffer_load_dwordx4 v[232:235], v3, s[48:51], s78 offen offset:2048 nt
	buffer_load_dwordx4 v[236:239], v3, s[48:51], s78 offen offset:3072 nt
	buffer_load_dwordx4 v[240:243], v4, s[48:51], s78 offen offset:0 nt
	buffer_load_dwordx4 v[244:247], v4, s[48:51], s78 offen offset:1024 nt
	buffer_load_dwordx4 v[248:251], v4, s[48:51], s78 offen offset:2048 nt
	buffer_load_dwordx4 v[252:255], v4, s[48:51], s78 offen offset:3072 nt
L_skv_33:
	v_pk_add_f32 v[28:29], v[32:33], v[34:35]
	v_pk_add_f32 v[30:31], v[36:37], v[38:39]
	v_pk_add_f32 v[28:29], v[28:29], v[30:31]
	v_add_f32 v28, v28, v29
	v_add_f32 v9, v9, v28
	s_nop 0
	s_branch L_S_loop
L_S_done:
	s_waitcnt vmcnt(0)
	v_mov_b32 v28, v9
	s_nop 1
	v_permlane16_swap_b32 v9, v28
	v_add_f32 v9, v9, v28
	v_mov_b32 v28, v9
	s_nop 1
	v_permlane32_swap_b32 v9, v28
	v_add_f32 v9, v9, v28
	v_lshlrev_b32 v28, 5, v0
	s_lshl_b32 s66, s36, 11
	v_add_u32 v28, s66, v28
	ds_write_b128 v28, v[40:43] offset:5120
	ds_write_b128 v28, v[44:47] offset:5136
	v_lshlrev_b32 v29, 3, v0
	s_lshl_b32 s66, s36, 3
	v_add_u32 v29, s66, v29
	s_mov_b64 exec, 0x1111
	ds_write_b64 v29, v[8:9] offset:13312
	s_mov_b64 exec, -1
	s_waitcnt lgkmcnt(0)
	s_barrier
	s_lshl_b32 s66, s36, 5
	v_mov_b32 v28, s66
	ds_read_b128 v[64:67], v28 offset:13312
	ds_read_b128 v[68:71], v28 offset:13328
	ds_read_b32 v90, v10 offset:14856
	s_lshl_b32 s66, s36, 9
	v_lshlrev_b32 v29, 3, v0
	v_add_u32 v29, s66, v29
	ds_read_b64 v[72:73], v29 offset:5120
	ds_read_b64 v[74:75], v29 offset:7168
	ds_read_b64 v[76:77], v29 offset:9216
	ds_read_b64 v[78:79], v29 offset:11264
	v_mov_b32 v85, s37
	v_mov_b32 v87, s37
	v_mov_b32 v81, s37
	v_mov_b32 v83, s37
	v_lshlrev_b32 v28, 4, v0
	s_waitcnt lgkmcnt(4)
	v_readfirstlane_b32 s66, v90
	v_max3_f32 v80, v64, v66, v68
	v_max_f32 v80, v80, v70
	v_sub_f32 v64, v64, v80
	v_sub_f32 v66, v66, v80
	v_sub_f32 v68, v68, v80
	v_sub_f32 v70, v70, v80
	v_exp_f32 v64, v64
	v_exp_f32 v66, v66
	v_exp_f32 v68, v68
	v_exp_f32 v70, v70
	v_mul_f32 v82, v64, v65
	v_fma_f32 v82, v66, v67, v82
	v_fma_f32 v82, v68, v69, v82
	v_fma_f32 v82, v70, v71, v82
	s_waitcnt lgkmcnt(0)
	v_mul_f32 v84, v64, v72
	v_mul_f32 v86, v64, v73
	v_fma_f32 v84, v66, v74, v84
	v_fma_f32 v86, v66, v75, v86
	v_fma_f32 v84, v68, v76, v84
	v_fma_f32 v86, v68, v77, v86
	v_fma_f32 v84, v70, v78, v84
	v_fma_f32 v86, v70, v79, v86
	s_cmp_eq_u32 s66, 0
	s_cbranch_scc1 L_S_pubslow
	buffer_store_dwordx4 v[84:87], v28, s[40:43], s67 offen
	s_mov_b64 exec, 1
	buffer_store_dwordx4 v[80:83], v10, s[40:43], s68 offen
	s_mov_b64 exec, -1
	s_branch L_S_pubdone
L_S_pubslow:
	buffer_store_dwordx4 v[84:87], v28, s[40:43], s67 offen sc1
	s_mov_b64 exec, 1
	buffer_store_dwordx4 v[80:83], v10, s[40:43], s68 offen sc1
	s_mov_b64 exec, -1
	s_nop 0
L_S_pubdone:
	v_lshrrev_b32 v28, 5, v0
	v_lshlrev_b32 v28, 12, v28
	v_and_b32 v29, 31, v0
	v_lshlrev_b32 v29, 4, v29
	v_add_u32 v28, v28, v29
	s_nop 1
L_S_poll:
	buffer_load_dwordx4 v[64:67], v28, s[40:43], s69 offen sc1
	buffer_load_dwordx4 v[68:71], v28, s[40:43], s70 offen sc1
	buffer_load_dwordx4 v[72:75], v28, s[40:43], s71 offen sc1
	buffer_load_dwordx4 v[76:79], v28, s[40:43], s72 offen sc1
	buffer_load_dwordx4 v[80:83], v29, s[40:43], s73 offen sc1
	s_waitcnt vmcnt(0)
	v_xor_b32 v30, s37, v65
	v_xor_b32 v31, s37, v67
	v_or_b32 v30, v30, v31
	v_xor_b32 v31, s37, v69
	v_or_b32 v30, v30, v31
	v_xor_b32 v31, s37, v71
	v_or_b32 v30, v30, v31
	v_xor_b32 v31, s37, v73
	v_or_b32 v30, v30, v31
	v_xor_b32 v31, s37, v75
	v_or_b32 v30, v30, v31
	v_xor_b32 v31, s37, v77
	v_or_b32 v30, v30, v31
	v_xor_b32 v31, s37, v79
	v_or_b32 v30, v30, v31
	v_xor_b32 v31, s37, v81
	v_or_b32 v30, v30, v31
	v_xor_b32 v31, s37, v83
	v_or_b32 v30, v30, v31
	v_cmp_ne_u32 vcc, 0, v30
	s_nop 3
	s_cbranch_vccz L_S_got
	s_sub_u32 s57, s57, 1
	s_cmp_eq_u32 s57, 0
	s_cbranch_scc1 L_S_got
	s_sleep 1
	s_branch L_S_poll
L_S_got:
	s_cmp_eq_u32 s36, 1
	s_cbranch_scc0 L_S_notk
	s_mov_b32 s52, s30
	s_mov_b32 s53, s31
	s_mov_b32 s54, 0x100
	s_mov_b32 s55, 0x00020000
	s_lshl_b32 s66, s35, 3
	v_mov_b32 v92, 1
	v_mov_b32 v93, s66
	s_mov_b64 exec, 1
	buffer_atomic_add v92, v93, s[52:55], 0 offen sc0 sc1
	s_mov_b64 exec, -1
L_S_notk:
	v_mov_b32 v30, v80
	s_nop 1
	v_max_f32_dpp v30, v30, v30 quad_perm:[1,0,3,2] row_mask:0xf bank_mask:0xf
	s_nop 1
	v_max_f32_dpp v30, v30, v30 quad_perm:[2,3,0,1] row_mask:0xf bank_mask:0xf
	s_nop 1
	v_max_f32_dpp v30, v30, v30 row_half_mirror row_mask:0xf bank_mask:0xf
	s_nop 1
	v_max_f32_dpp v30, v30, v30 row_mirror row_mask:0xf bank_mask:0xf
	v_mov_b32 v31, v30
	s_nop 1
	v_permlane16_swap_b32 v30, v31
	v_max_f32 v30, v30, v31
	v_mov_b32 v31, v30
	s_nop 1
	v_permlane32_swap_b32 v30, v31
	v_max_f32 v30, v30, v31
	v_sub_f32 v80, v80, v30
	v_exp_f32 v80, v80
	s_nop 0
	v_mul_f32 v82, v80, v82
	s_nop 1
	v_add_f32_dpp v82, v82, v82 quad_perm:[1,0,3,2] row_mask:0xf bank_mask:0xf
	s_nop 1
	v_add_f32_dpp v82, v82, v82 quad_perm:[2,3,0,1] row_mask:0xf bank_mask:0xf
	s_nop 1
	v_add_f32_dpp v82, v82, v82 row_half_mirror row_mask:0xf bank_mask:0xf
	s_nop 1
	v_add_f32_dpp v82, v82, v82 row_mirror row_mask:0xf bank_mask:0xf
	v_mov_b32 v31, v82
	s_nop 1
	v_permlane16_swap_b32 v82, v31
	v_add_f32 v82, v82, v31
	v_mov_b32 v31, v82
	s_nop 1
	v_permlane32_swap_b32 v82, v31
	v_add_f32 v82, v82, v31
	v_rcp_f32 v82, v82
	v_add_f32 v80, v80, v80
	v_mul_f32 v80, v80, v82
	v_lshrrev_b32 v30, 5, v0
	s_lshl_b32 s66, s36, 3
	v_add_u32 v30, s66, v30
	v_lshlrev_b32 v30, 2, v30
	ds_bpermute_b32 v84, v30, v80
	v_add_u32 v30, 8, v30
	ds_bpermute_b32 v85, v30, v80
	v_add_u32 v30, 8, v30
	ds_bpermute_b32 v86, v30, v80
	v_add_u32 v30, 8, v30
	ds_bpermute_b32 v87, v30, v80
	s_waitcnt lgkmcnt(0)
	v_mul_f32 v88, v84, v64
	v_mul_f32 v89, v84, v66
	v_fma_f32 v88, v85, v68, v88
	v_fma_f32 v89, v85, v70, v89
	v_fma_f32 v88, v86, v72, v88
	v_fma_f32 v89, v86, v74, v89
	v_fma_f32 v88, v87, v76, v88
	v_fma_f32 v89, v87, v78, v89
	v_mov_b32 v90, v88
	v_mov_b32 v91, v89
	s_nop 0
	v_permlane32_swap_b32 v88, v90
	v_permlane32_swap_b32 v89, v91
	v_add_f32 v88, v88, v90
	v_add_f32 v89, v89, v91
	v_and_b32 v30, 31, v0
	v_lshlrev_b32 v30, 3, v30
	s_lshl_b32 s66, s36, 8
	v_add_u32 v30, s66, v30
	ds_write_b64 v30, v[88:89] offset:13568
	s_waitcnt lgkmcnt(0)
	s_barrier
	s_cmp_eq_u32 s36, 1
	s_cbranch_scc0 L_S_notk2
	v_mov_b32 v93, 15168
	s_waitcnt vmcnt(0)
	v_add_u32 v92, 1, v92
	s_mov_b64 exec, 1
	ds_write_b32 v93, v92
	s_mov_b64 exec, -1
	s_waitcnt lgkmcnt(0)
L_S_notk2:
	s_branch L_end
L_F:
	s_setprio 3
	s_mov_b32 s44, s8
	s_mov_b32 s45, s9
	s_mov_b32 s46, 0x400
	s_mov_b32 s47, 0x00020000
	s_mov_b32 s48, s20
	s_mov_b32 s49, s21
	s_mov_b32 s50, 0x400
	s_mov_b32 s51, 0x00020000
	v_lshlrev_b32 v3, 4, v0
	buffer_load_dwordx4 v[4:7], v3, s[44:47], 0 offen
	buffer_load_dwordx4 v[8:11], v3, s[48:51], 0 offen
	s_cmp_lt_u32 s34, 8
	s_cbranch_scc0 L_F_nold
	s_lshl_b32 s38, s34, 5
	s_add_u32 s38, s38, s35
	s_sub_u32 s39, s36, 4
	s_and_b32 s100, s38, 63
	s_lshr_b32 s101, s38, 6
	s_mul_i32 s39, s39, 64
	s_mul_i32 s66, s101, 128
	s_add_u32 s39, s39, s66
	s_lshl_b32 s66, s100, 7
	s_lshl_b32 s67, s39, 13
	s_add_u32 s66, s66, s67
	s_add_u32 s52, s14, s66
	s_addc_u32 s53, s15, 0
	s_sub_u32 s54, 4194304, s66
	s_mov_b32 s55, 0x00020000
	v_lshrrev_b32 v1, 3, v0
	v_lshlrev_b32 v1, 13, v1
	v_and_b32 v2, 7, v0
	v_lshlrev_b32 v2, 4, v2
	v_add_u32 v1, v1, v2
	s_mov_b32 s56, 0
	buffer_load_dwordx4 v[64:67], v1, s[52:55], s56 offen nt
	s_add_u32 s56, s56, 65536
	buffer_load_dwordx4 v[68:71], v1, s[52:55], s56 offen nt
	s_add_u32 s56, s56, 65536
	buffer_load_dwordx4 v[72:75], v1, s[52:55], s56 offen nt
	s_add_u32 s56, s56, 65536
	buffer_load_dwordx4 v[76:79], v1, s[52:55], s56 offen nt
	s_add_u32 s56, s56, 65536
	buffer_load_dwordx4 v[80:83], v1, s[52:55], s56 offen nt
	s_add_u32 s56, s56, 65536
	buffer_load_dwordx4 v[84:87], v1, s[52:55], s56 offen nt
	s_add_u32 s56, s56, 65536
	buffer_load_dwordx4 v[88:91], v1, s[52:55], s56 offen nt
	s_add_u32 s56, s56, 65536
	buffer_load_dwordx4 v[92:95], v1, s[52:55], s56 offen nt
L_F_nold:
	v_mov_b32 v12, 14852
	v_mov_b32 v13, 12
	v_mov_b32 v14, 0
	ds_write_b32 v12, v13
	ds_write_b32 v12, v14 offset:8
	s_waitcnt lgkmcnt(0)
	s_barrier
	s_add_u32 s37, s37, 1
	s_cmp_lt_u32 s34, 8
	s_cbranch_scc1 L_F_q
	s_cmp_eq_u32 s36, 5
	s_cbranch_scc1 L_W
	s_waitcnt vmcnt(0)
	s_branch L_F_ln
L_F_q:
	s_waitcnt vmcnt(9)
L_F_ln:
	v_lshlrev_b32 v16, 16, v4
	v_and_b32 v17, s58, v4
	v_lshlrev_b32 v18, 16, v5
	v_and_b32 v19, s58, v5
	v_lshlrev_b32 v20, 16, v6
	v_and_b32 v21, s58, v6
	v_lshlrev_b32 v22, 16, v7
	v_and_b32 v23, s58, v7
	v_pk_add_f32 v[24:25], v[16:17], v[18:19]
	v_pk_add_f32 v[26:27], v[20:21], v[22:23]
	v_pk_add_f32 v[24:25], v[24:25], v[26:27]
	v_add_f32 v24, v24, v25
	s_nop 1
	v_add_f32_dpp v24, v24, v24 quad_perm:[1,0,3,2] row_mask:0xf bank_mask:0xf
	s_nop 1
	v_add_f32_dpp v24, v24, v24 quad_perm:[2,3,0,1] row_mask:0xf bank_mask:0xf
	s_nop 1
	v_add_f32_dpp v24, v24, v24 row_half_mirror row_mask:0xf bank_mask:0xf
	s_nop 1
	v_add_f32_dpp v24, v24, v24 row_mirror row_mask:0xf bank_mask:0xf
	v_mov_b32 v25, v24
	s_nop 1
	v_permlane16_swap_b32 v24, v25
	v_add_f32 v24, v24, v25
	v_mov_b32 v25, v24
	s_nop 1
	v_permlane32_swap_b32 v24, v25
	v_add_f32 v24, v24, v25
	v_mul_f32 v24, 0x3b000000, v24
	v_sub_f32 v28, v16, v24
	v_sub_f32 v29, v17, v24
	v_sub_f32 v30, v18, v24
	v_sub_f32 v31, v19, v24
	v_sub_f32 v32, v20, v24
	v_sub_f32 v33, v21, v24
	v_sub_f32 v34, v22, v24
	v_sub_f32 v35, v23, v24
	v_mul_f32 v26, v28, v28
	v_fma_f32 v26, v29, v29, v26
	v_fma_f32 v26, v30, v30, v26
	v_fma_f32 v26, v31, v31, v26
	v_fma_f32 v26, v32, v32, v26
	v_fma_f32 v26, v33, v33, v26
	v_fma_f32 v26, v34, v34, v26
	v_fma_f32 v26, v35, v35, v26
	s_nop 1
	v_add_f32_dpp v26, v26, v26 quad_perm:[1,0,3,2] row_mask:0xf bank_mask:0xf
	s_nop 1
	v_add_f32_dpp v26, v26, v26 quad_perm:[2,3,0,1] row_mask:0xf bank_mask:0xf
	s_nop 1
	v_add_f32_dpp v26, v26, v26 row_half_mirror row_mask:0xf bank_mask:0xf
	s_nop 1
	v_add_f32_dpp v26, v26, v26 row_mirror row_mask:0xf bank_mask:0xf
	v_mov_b32 v25, v26
	s_nop 1
	v_permlane16_swap_b32 v26, v25
	v_add_f32 v26, v26, v25
	v_mov_b32 v25, v26
	s_nop 1
	v_permlane32_swap_b32 v26, v25
	v_add_f32 v26, v26, v25
	v_mul_f32 v26, 0x3b000000, v26
	v_cvt_pk_bf16_f32 v24, v24, v24
	v_and_b32 v24, s58, v24
	v_cvt_pk_bf16_f32 v26, v26, v26
	v_and_b32 v26, s58, v26
	v_add_f32 v26, 0x3727c5ac, v26
	v_cvt_pk_bf16_f32 v26, v26, v26
	v_and_b32 v26, s58, v26
	v_sqrt_f32 v26, v26
	s_nop 0
	v_cvt_pk_bf16_f32 v26, v26, v26
	v_and_b32 v26, s58, v26
	v_rcp_f32 v26, v26
	v_sub_f32 v16, v16, v24
	v_sub_f32 v17, v17, v24
	v_sub_f32 v18, v18, v24
	v_sub_f32 v19, v19, v24
	v_sub_f32 v20, v20, v24
	v_sub_f32 v21, v21, v24
	v_sub_f32 v22, v22, v24
	v_sub_f32 v23, v23, v24
	v_cvt_pk_bf16_f32 v28, v16, v17
	v_cvt_pk_bf16_f32 v29, v18, v19
	v_cvt_pk_bf16_f32 v30, v20, v21
	v_cvt_pk_bf16_f32 v31, v22, v23
	v_lshlrev_b32 v16, 16, v28
	v_and_b32 v17, s58, v28
	v_lshlrev_b32 v18, 16, v29
	v_and_b32 v19, s58, v29
	v_lshlrev_b32 v20, 16, v30
	v_and_b32 v21, s58, v30
	v_lshlrev_b32 v22, 16, v31
	v_and_b32 v23, s58, v31
	v_mul_f32 v16, v16, v26
	v_mul_f32 v17, v17, v26
	v_mul_f32 v18, v18, v26
	v_mul_f32 v19, v19, v26
	v_mul_f32 v20, v20, v26
	v_mul_f32 v21, v21, v26
	v_mul_f32 v22, v22, v26
	v_mul_f32 v23, v23, v26
	v_cvt_pk_bf16_f32 v12, v16, v17
	v_cvt_pk_bf16_f32 v13, v18, v19
	v_cvt_pk_bf16_f32 v14, v20, v21
	v_cvt_pk_bf16_f32 v15, v22, v23
	v_lshlrev_b32 v2, 6, v0
	v_and_b32 v28, 0xffff, v12
	v_lshlrev_b32 v29, 16, v12
	v_lshrrev_b32 v30, 16, v12
	v_and_b32 v31, s58, v12
	ds_write_b128 v2, v[28:31] offset:0
	s_nop 1
	v_and_b32 v28, 0xffff, v13
	v_lshlrev_b32 v29, 16, v13
	v_lshrrev_b32 v30, 16, v13
	v_and_b32 v31, s58, v13
	ds_write_b128 v2, v[28:31] offset:16
	s_nop 1
	v_and_b32 v28, 0xffff, v14
	v_lshlrev_b32 v29, 16, v14
	v_lshrrev_b32 v30, 16, v14
	v_and_b32 v31, s58, v14
	ds_write_b128 v2, v[28:31] offset:32
	s_nop 1
	v_and_b32 v28, 0xffff, v15
	v_lshlrev_b32 v29, 16, v15
	v_lshrrev_b32 v30, 16, v15
	v_and_b32 v31, s58, v15
	ds_write_b128 v2, v[28:31] offset:48
	s_waitcnt lgkmcnt(0)
	s_cmp_lt_u32 s34, 8
	s_cbranch_scc0 L_F_done
	v_lshrrev_b32 v2, 3, v0
	v_lshlrev_b32 v2, 3, v2
	s_lshl_b32 s66, s39, 3
	v_add_u32 v2, s66, v2
	ds_read_b64 v[192:193], v2 offset:0
	ds_read_b64 v[194:195], v2 offset:64
	ds_read_b64 v[196:197], v2 offset:128
	ds_read_b64 v[198:199], v2 offset:192
	ds_read_b64 v[200:201], v2 offset:256
	ds_read_b64 v[202:203], v2 offset:320
	ds_read_b64 v[204:205], v2 offset:384
	ds_read_b64 v[206:207], v2 offset:448
	s_waitcnt lgkmcnt(0)
	v_mov_b32 v16, 0
	v_mov_b32 v17, 0
	v_mov_b32 v18, 0
	v_mov_b32 v19, 0
	v_mov_b32 v20, 0
	v_mov_b32 v21, 0
	v_mov_b32 v22, 0
	v_mov_b32 v23, 0
	s_waitcnt vmcnt(7)
	v_dot2c_f32_bf16 v16, v64, v192
	v_dot2c_f32_bf16 v17, v64, v193
	v_dot2c_f32_bf16 v18, v65, v192
	v_dot2c_f32_bf16 v19, v65, v193
	v_dot2c_f32_bf16 v20, v66, v192
	v_dot2c_f32_bf16 v21, v66, v193
	v_dot2c_f32_bf16 v22, v67, v192
	v_dot2c_f32_bf16 v23, v67, v193
	s_waitcnt vmcnt(6)
	v_dot2c_f32_bf16 v16, v68, v194
	v_dot2c_f32_bf16 v17, v68, v195
	v_dot2c_f32_bf16 v18, v69, v194
	v_dot2c_f32_bf16 v19, v69, v195
	v_dot2c_f32_bf16 v20, v70, v194
	v_dot2c_f32_bf16 v21, v70, v195
	v_dot2c_f32_bf16 v22, v71, v194
	v_dot2c_f32_bf16 v23, v71, v195
	s_waitcnt vmcnt(5)
	v_dot2c_f32_bf16 v16, v72, v196
	v_dot2c_f32_bf16 v17, v72, v197
	v_dot2c_f32_bf16 v18, v73, v196
	v_dot2c_f32_bf16 v19, v73, v197
	v_dot2c_f32_bf16 v20, v74, v196
	v_dot2c_f32_bf16 v21, v74, v197
	v_dot2c_f32_bf16 v22, v75, v196
	v_dot2c_f32_bf16 v23, v75, v197
	s_waitcnt vmcnt(4)
	v_dot2c_f32_bf16 v16, v76, v198
	v_dot2c_f32_bf16 v17, v76, v199
	v_dot2c_f32_bf16 v18, v77, v198
	v_dot2c_f32_bf16 v19, v77, v199
	v_dot2c_f32_bf16 v20, v78, v198
	v_dot2c_f32_bf16 v21, v78, v199
	v_dot2c_f32_bf16 v22, v79, v198
	v_dot2c_f32_bf16 v23, v79, v199
	s_waitcnt vmcnt(3)
	v_dot2c_f32_bf16 v16, v80, v200
	v_dot2c_f32_bf16 v17, v80, v201
	v_dot2c_f32_bf16 v18, v81, v200
	v_dot2c_f32_bf16 v19, v81, v201
	v_dot2c_f32_bf16 v20, v82, v200
	v_dot2c_f32_bf16 v21, v82, v201
	v_dot2c_f32_bf16 v22, v83, v200
	v_dot2c_f32_bf16 v23, v83, v201
	s_waitcnt vmcnt(2)
	v_dot2c_f32_bf16 v16, v84, v202
	v_dot2c_f32_bf16 v17, v84, v203
	v_dot2c_f32_bf16 v18, v85, v202
	v_dot2c_f32_bf16 v19, v85, v203
	v_dot2c_f32_bf16 v20, v86, v202
	v_dot2c_f32_bf16 v21, v86, v203
	v_dot2c_f32_bf16 v22, v87, v202
	v_dot2c_f32_bf16 v23, v87, v203
	s_waitcnt vmcnt(1)
	v_dot2c_f32_bf16 v16, v88, v204
	v_dot2c_f32_bf16 v17, v88, v205
	v_dot2c_f32_bf16 v18, v89, v204
	v_dot2c_f32_bf16 v19, v89, v205
	v_dot2c_f32_bf16 v20, v90, v204
	v_dot2c_f32_bf16 v21, v90, v205
	v_dot2c_f32_bf16 v22, v91, v204
	v_dot2c_f32_bf16 v23, v91, v205
	s_waitcnt vmcnt(0)
	v_dot2c_f32_bf16 v16, v92, v206
	v_dot2c_f32_bf16 v17, v92, v207
	v_dot2c_f32_bf16 v18, v93, v206
	v_dot2c_f32_bf16 v19, v93, v207
	v_dot2c_f32_bf16 v20, v94, v206
	v_dot2c_f32_bf16 v21, v94, v207
	v_dot2c_f32_bf16 v22, v95, v206
	v_dot2c_f32_bf16 v23, v95, v207
	v_permlane32_swap_b32 v16, v20
	v_permlane32_swap_b32 v17, v21
	v_permlane32_swap_b32 v18, v22
	v_permlane32_swap_b32 v19, v23
	v_add_f32 v16, v16, v20
	v_add_f32 v17, v17, v21
	v_add_f32 v18, v18, v22
	v_add_f32 v19, v19, v23
	s_nop 0
	v_permlane16_swap_b32 v16, v18
	v_permlane16_swap_b32 v17, v19
	v_add_f32 v24, v16, v18
	v_add_f32 v25, v17, v19
	s_nop 0
	v_add_f32_dpp v24, v24, v24 row_ror:8 row_mask:0xf bank_mask:0xf
	v_add_f32_dpp v25, v25, v25 row_ror:8 row_mask:0xf bank_mask:0xf
	v_lshlrev_b32 v2, 3, v0
	v_mov_b32 v3, 14860
	s_cmp_eq_u32 s36, 5
	s_cbranch_scc0 L_F_comb
	ds_write_b64 v2, v[24:25] offset:5120
	v_mov_b32 v26, 1
	s_waitcnt lgkmcnt(0)
	ds_write_b32 v3, v26
	s_waitcnt lgkmcnt(0)
	s_branch L_W
L_F_comb:
	ds_read_b32 v26, v3
	s_waitcnt lgkmcnt(0)
	v_cmp_eq_u32 vcc, 0, v26
	s_nop 3
	s_cbranch_vccz L_F_cgot
	s_sub_u32 s57, s57, 1
	s_cmp_eq_u32 s57, 0
	s_cbranch_scc1 L_F_cgot
	s_branch L_F_comb
L_F_cgot:
	ds_read_b64 v[26:27], v2 offset:5120
	s_waitcnt lgkmcnt(0)
	v_add_f32 v24, v24, v26
	v_add_f32 v25, v25, v27
	v_mov_b32 v26, v25
	v_mov_b32 v25, s37
	v_mov_b32 v27, s37
	v_and_b32 v2, 7, v0
	v_lshlrev_b32 v2, 6, v2
	v_lshrrev_b32 v3, 4, v0
	v_lshlrev_b32 v3, 4, v3
	v_add_u32 v2, v2, v3
	s_lshl_b32 s67, s101, 15
	s_lshl_b32 s66, s100, 9
	s_add_u32 s67, s67, s66
	s_add_u32 s67, s67, 524288
	s_mov_b32 exec_lo, 0x00ff00ff
	s_mov_b32 exec_hi, 0x00ff00ff
	buffer_store_dwordx4 v[24:27], v2, s[40:43], s67 offen sc1
	s_mov_b64 exec, -1
	s_mov_b32 s57, 40000
L_F_done:
	s_lshl_b32 s66, s34, 11
	s_add_u32 s66, s66, 4096
	v_mov_b32 v28, 0
	v_dot2c_f32_bf16 v28, v12, v8
	v_dot2c_f32_bf16 v28, v13, v9
	v_dot2c_f32_bf16 v28, v14, v10
	v_dot2c_f32_bf16 v28, v15, v11
	s_nop 2
	v_add_f32_dpp v28, v28, v28 quad_perm:[1,0,3,2] row_mask:0xf bank_mask:0xf
	s_nop 1
	v_add_f32_dpp v28, v28, v28 quad_perm:[2,3,0,1] row_mask:0xf bank_mask:0xf
	s_nop 1
	v_add_f32_dpp v28, v28, v28 row_half_mirror row_mask:0xf bank_mask:0xf
	s_nop 1
	v_add_f32_dpp v28, v28, v28 row_mirror row_mask:0xf bank_mask:0xf
	v_mov_b32 v29, v28
	s_nop 1
	v_permlane16_swap_b32 v28, v29
	v_add_f32 v28, v28, v29
	v_mov_b32 v29, v28
	s_nop 1
	v_permlane32_swap_b32 v28, v29
	v_add_f32 v28, v28, v29
	v_cvt_pk_bf16_f32 v28, v28, v28
	v_and_b32 v28, s58, v28
	v_mul_f32 v28, s59, v28
	v_sub_f32 v28, 0, v28
	v_exp_f32 v28, v28
	s_nop 0
	v_add_f32 v28, 1.0, v28
	v_rcp_f32 v28, v28
	s_nop 0
	v_cvt_pk_bf16_f32 v28, v28, v28
	v_and_b32 v28, s58, v28
	v_mov_b32 v29, 14848
	ds_write_b32 v29, v28
	v_lshlrev_b32 v2, 4, v0
	v_lshlrev_b32 v3, 2, v0
	s_lshl_b32 s66, s34, 12
	s_add_u32 s66, s66, 524288
	s_lshl_b32 s67, s34, 12
	s_add_u32 s67, s67, 557056
	s_lshl_b32 s68, s34, 12
	s_add_u32 s68, s68, 589824
	s_lshl_b32 s69, s34, 12
	s_add_u32 s69, s69, 622592
	buffer_load_dwordx4 v[64:67], v2, s[40:43], s66 offen offset:0 sc1
	buffer_load_dwordx4 v[68:71], v2, s[40:43], s66 offen offset:1024 sc1
	buffer_load_dwordx4 v[72:75], v2, s[40:43], s66 offen offset:2048 sc1
	buffer_load_dwordx4 v[76:79], v2, s[40:43], s66 offen offset:3072 sc1
	buffer_load_dwordx4 v[80:83], v2, s[40:43], s67 offen offset:0 sc1
	buffer_load_dwordx4 v[84:87], v2, s[40:43], s67 offen offset:1024 sc1
	buffer_load_dwordx4 v[88:91], v2, s[40:43], s67 offen offset:2048 sc1
	buffer_load_dwordx4 v[92:95], v2, s[40:43], s67 offen offset:3072 sc1
	buffer_load_dwordx4 v[96:99], v2, s[40:43], s68 offen offset:0 sc1
	buffer_load_dwordx4 v[100:103], v2, s[40:43], s68 offen offset:1024 sc1
	buffer_load_dwordx4 v[104:107], v2, s[40:43], s68 offen offset:2048 sc1
	buffer_load_dwordx4 v[108:111], v2, s[40:43], s68 offen offset:3072 sc1
	buffer_load_dwordx4 v[112:115], v2, s[40:43], s69 offen offset:0 sc1
	buffer_load_dwordx4 v[116:119], v2, s[40:43], s69 offen offset:1024 sc1
	buffer_load_dwordx4 v[120:123], v2, s[40:43], s69 offen offset:2048 sc1
	buffer_load_dwordx4 v[124:127], v2, s[40:43], s69 offen offset:3072 sc1
L_Q_chk:
	s_waitcnt vmcnt(0)
	s_mov_b32 s70, 0
	v_xor_b32 v30, s37, v65
	v_xor_b32 v31, s37, v67
	v_or_b32 v30, v30, v31
	v_cmp_ne_u32 vcc, 0, v30
	s_nop 3
	s_cbranch_vccz L_ok_34
	buffer_load_dwordx4 v[64:67], v2, s[40:43], s66 offen offset:0 sc1
	s_mov_b32 s70, 1
L_ok_34:
	v_xor_b32 v30, s37, v69
	v_xor_b32 v31, s37, v71
	v_or_b32 v30, v30, v31
	v_cmp_ne_u32 vcc, 0, v30
	s_nop 3
	s_cbranch_vccz L_ok_35
	buffer_load_dwordx4 v[68:71], v2, s[40:43], s66 offen offset:1024 sc1
	s_mov_b32 s70, 1
L_ok_35:
	v_xor_b32 v30, s37, v73
	v_xor_b32 v31, s37, v75
	v_or_b32 v30, v30, v31
	v_cmp_ne_u32 vcc, 0, v30
	s_nop 3
	s_cbranch_vccz L_ok_36
	buffer_load_dwordx4 v[72:75], v2, s[40:43], s66 offen offset:2048 sc1
	s_mov_b32 s70, 1
L_ok_36:
	v_xor_b32 v30, s37, v77
	v_xor_b32 v31, s37, v79
	v_or_b32 v30, v30, v31
	v_cmp_ne_u32 vcc, 0, v30
	s_nop 3
	s_cbranch_vccz L_ok_37
	buffer_load_dwordx4 v[76:79], v2, s[40:43], s66 offen offset:3072 sc1
	s_mov_b32 s70, 1
L_ok_37:
	v_xor_b32 v30, s37, v81
	v_xor_b32 v31, s37, v83
	v_or_b32 v30, v30, v31
	v_cmp_ne_u32 vcc, 0, v30
	s_nop 3
	s_cbranch_vccz L_ok_38
	buffer_load_dwordx4 v[80:83], v2, s[40:43], s67 offen offset:0 sc1
	s_mov_b32 s70, 1
L_ok_38:
	v_xor_b32 v30, s37, v85
	v_xor_b32 v31, s37, v87
	v_or_b32 v30, v30, v31
	v_cmp_ne_u32 vcc, 0, v30
	s_nop 3
	s_cbranch_vccz L_ok_39
	buffer_load_dwordx4 v[84:87], v2, s[40:43], s67 offen offset:1024 sc1
	s_mov_b32 s70, 1
L_ok_39:
	v_xor_b32 v30, s37, v89
	v_xor_b32 v31, s37, v91
	v_or_b32 v30, v30, v31
	v_cmp_ne_u32 vcc, 0, v30
	s_nop 3
	s_cbranch_vccz L_ok_40
	buffer_load_dwordx4 v[88:91], v2, s[40:43], s67 offen offset:2048 sc1
	s_mov_b32 s70, 1
L_ok_40:
	v_xor_b32 v30, s37, v93
	v_xor_b32 v31, s37, v95
	v_or_b32 v30, v30, v31
	v_cmp_ne_u32 vcc, 0, v30
	s_nop 3
	s_cbranch_vccz L_ok_41
	buffer_load_dwordx4 v[92:95], v2, s[40:43], s67 offen offset:3072 sc1
	s_mov_b32 s70, 1
L_ok_41:
	v_xor_b32 v30, s37, v97
	v_xor_b32 v31, s37, v99
	v_or_b32 v30, v30, v31
	v_cmp_ne_u32 vcc, 0, v30
	s_nop 3
	s_cbranch_vccz L_ok_42
	buffer_load_dwordx4 v[96:99], v2, s[40:43], s68 offen offset:0 sc1
	s_mov_b32 s70, 1
L_ok_42:
	v_xor_b32 v30, s37, v101
	v_xor_b32 v31, s37, v103
	v_or_b32 v30, v30, v31
	v_cmp_ne_u32 vcc, 0, v30
	s_nop 3
	s_cbranch_vccz L_ok_43
	buffer_load_dwordx4 v[100:103], v2, s[40:43], s68 offen offset:1024 sc1
	s_mov_b32 s70, 1
L_ok_43:
	v_xor_b32 v30, s37, v105
	v_xor_b32 v31, s37, v107
	v_or_b32 v30, v30, v31
	v_cmp_ne_u32 vcc, 0, v30
	s_nop 3
	s_cbranch_vccz L_ok_44
	buffer_load_dwordx4 v[104:107], v2, s[40:43], s68 offen offset:2048 sc1
	s_mov_b32 s70, 1
L_ok_44:
	v_xor_b32 v30, s37, v109
	v_xor_b32 v31, s37, v111
	v_or_b32 v30, v30, v31
	v_cmp_ne_u32 vcc, 0, v30
	s_nop 3
	s_cbranch_vccz L_ok_45
	buffer_load_dwordx4 v[108:111], v2, s[40:43], s68 offen offset:3072 sc1
	s_mov_b32 s70, 1
L_ok_45:
	v_xor_b32 v30, s37, v113
	v_xor_b32 v31, s37, v115
	v_or_b32 v30, v30, v31
	v_cmp_ne_u32 vcc, 0, v30
	s_nop 3
	s_cbranch_vccz L_ok_46
	buffer_load_dwordx4 v[112:115], v2, s[40:43], s69 offen offset:0 sc1
	s_mov_b32 s70, 1
L_ok_46:
	v_xor_b32 v30, s37, v117
	v_xor_b32 v31, s37, v119
	v_or_b32 v30, v30, v31
	v_cmp_ne_u32 vcc, 0, v30
	s_nop 3
	s_cbranch_vccz L_ok_47
	buffer_load_dwordx4 v[116:119], v2, s[40:43], s69 offen offset:1024 sc1
	s_mov_b32 s70, 1
L_ok_47:
	v_xor_b32 v30, s37, v121
	v_xor_b32 v31, s37, v123
	v_or_b32 v30, v30, v31
	v_cmp_ne_u32 vcc, 0, v30
	s_nop 3
	s_cbranch_vccz L_ok_48
	buffer_load_dwordx4 v[120:123], v2, s[40:43], s69 offen offset:2048 sc1
	s_mov_b32 s70, 1
L_ok_48:
	v_xor_b32 v30, s37, v125
	v_xor_b32 v31, s37, v127
	v_or_b32 v30, v30, v31
	v_cmp_ne_u32 vcc, 0, v30
	s_nop 3
	s_cbranch_vccz L_ok_49
	buffer_load_dwordx4 v[124:127], v2, s[40:43], s69 offen offset:3072 sc1
	s_mov_b32 s70, 1
L_ok_49:
	s_cmp_eq_u32 s70, 0
	s_cbranch_scc1 L_Q_got
	s_sub_u32 s57, s57, 1
	s_cmp_eq_u32 s57, 0
	s_cbranch_scc1 L_Q_got
	s_sleep 1
	s_branch L_Q_chk
L_Q_got:
	s_waitcnt vmcnt(0)
	v_add_u32 v3, 4096, v3
	v_add_f32 v64, v64, v80
	v_add_f32 v66, v66, v82
	v_add_f32 v64, v64, v96
	v_add_f32 v66, v66, v98
	v_add_f32 v64, v64, v112
	v_add_f32 v66, v66, v114
	v_cvt_pk_bf16_f32 v32, v64, v66
	ds_write_b32 v3, v32 offset:0
	v_add_f32 v68, v68, v84
	v_add_f32 v70, v70, v86
	v_add_f32 v68, v68, v100
	v_add_f32 v70, v70, v102
	v_add_f32 v68, v68, v116
	v_add_f32 v70, v70, v118
	v_cvt_pk_bf16_f32 v33, v68, v70
	ds_write_b32 v3, v33 offset:256
	v_add_f32 v72, v72, v88
	v_add_f32 v74, v74, v90
	v_add_f32 v72, v72, v104
	v_add_f32 v74, v74, v106
	v_add_f32 v72, v72, v120
	v_add_f32 v74, v74, v122
	v_cvt_pk_bf16_f32 v34, v72, v74
	ds_write_b32 v3, v34 offset:512
	v_add_f32 v76, v76, v92
	v_add_f32 v78, v78, v94
	v_add_f32 v76, v76, v108
	v_add_f32 v78, v78, v110
	v_add_f32 v76, v76, v124
	v_add_f32 v78, v78, v126
	v_cvt_pk_bf16_f32 v35, v76, v78
	ds_write_b32 v3, v35 offset:768
	s_waitcnt lgkmcnt(0)
	s_barrier
	s_cmp_ge_u32 s35, 28
	s_cbranch_scc1 L_Q_end
	s_mul_i32 s70, s34, 28
	s_add_u32 s70, s70, s35
	s_cmp_ge_u32 s70, 112
	s_cselect_b32 s71, 1, 0
	s_mul_i32 s66, s71, 112
	s_sub_u32 s70, s70, s66
	s_lshr_b32 s72, s70, 2
	s_and_b32 s73, s70, 3
	s_mul_i32 s66, s73, 458752
	s_lshl_b32 s67, s72, 7
	s_add_u32 s66, s66, s67
	s_cmp_eq_u32 s71, 0
	s_cbranch_scc0 L_Q_up
	s_add_u32 s52, s22, s66
	s_addc_u32 s53, s23, 0
	s_branch L_Q_srd
L_Q_up:
	s_add_u32 s52, s24, s66
	s_addc_u32 s53, s25, 0
L_Q_srd:
	s_sub_u32 s54, 1835008, s66
	s_mov_b32 s55, 0x00020000
	v_lshrrev_b32 v1, 3, v0
	s_mov_b32 s68, 3584
	v_mul_lo_u32 v1, v1, s68
	v_and_b32 v2, 7, v0
	v_lshlrev_b32 v2, 4, v2
	v_add_u32 v1, v1, v2
	s_mov_b32 s56, 0
	buffer_load_dwordx4 v[64:67], v1, s[52:55], s56 offen nt
	s_add_u32 s56, s56, 28672
	buffer_load_dwordx4 v[68:71], v1, s[52:55], s56 offen nt
	s_add_u32 s56, s56, 28672
	buffer_load_dwordx4 v[72:75], v1, s[52:55], s56 offen nt
	s_add_u32 s56, s56, 28672
	buffer_load_dwordx4 v[76:79], v1, s[52:55], s56 offen nt
	s_add_u32 s56, s56, 28672
	buffer_load_dwordx4 v[80:83], v1, s[52:55], s56 offen nt
	s_add_u32 s56, s56, 28672
	buffer_load_dwordx4 v[84:87], v1, s[52:55], s56 offen nt
	s_add_u32 s56, s56, 28672
	buffer_load_dwordx4 v[88:91], v1, s[52:55], s56 offen nt
	s_add_u32 s56, s56, 28672
	buffer_load_dwordx4 v[92:95], v1, s[52:55], s56 offen nt
	s_add_u32 s56, s56, 28672
	buffer_load_dwordx4 v[96:99], v1, s[52:55], s56 offen nt
	s_add_u32 s56, s56, 28672
	buffer_load_dwordx4 v[100:103], v1, s[52:55], s56 offen nt
	s_add_u32 s56, s56, 28672
	buffer_load_dwordx4 v[104:107], v1, s[52:55], s56 offen nt
	s_add_u32 s56, s56, 28672
	buffer_load_dwordx4 v[108:111], v1, s[52:55], s56 offen nt
	s_add_u32 s56, s56, 28672
	buffer_load_dwordx4 v[112:115], v1, s[52:55], s56 offen nt
	s_add_u32 s56, s56, 28672
	buffer_load_dwordx4 v[116:119], v1, s[52:55], s56 offen nt
	s_add_u32 s56, s56, 28672
	buffer_load_dwordx4 v[120:123], v1, s[52:55], s56 offen nt
	s_add_u32 s56, s56, 28672
	buffer_load_dwordx4 v[124:127], v1, s[52:55], s56 offen nt
	v_lshrrev_b32 v2, 3, v0
	v_lshlrev_b32 v2, 3, v2
	s_lshl_b32 s66, s73, 10
	v_add_u32 v2, s66, v2
	ds_read_b64 v[128:129], v2 offset:0
	ds_read_b64 v[130:131], v2 offset:64
	ds_read_b64 v[132:133], v2 offset:128
	ds_read_b64 v[134:135], v2 offset:192
	ds_read_b64 v[136:137], v2 offset:256
	ds_read_b64 v[138:139], v2 offset:320
	ds_read_b64 v[140:141], v2 offset:384
	ds_read_b64 v[142:143], v2 offset:448
	ds_read_b64 v[144:145], v2 offset:512
	ds_read_b64 v[146:147], v2 offset:576
	ds_read_b64 v[148:149], v2 offset:640
	ds_read_b64 v[150:151], v2 offset:704
	ds_read_b64 v[152:153], v2 offset:768
	ds_read_b64 v[154:155], v2 offset:832
	ds_read_b64 v[156:157], v2 offset:896
	ds_read_b64 v[158:159], v2 offset:960
	s_waitcnt lgkmcnt(0)
	v_mov_b32 v16, 0
	v_mov_b32 v17, 0
	v_mov_b32 v18, 0
	v_mov_b32 v19, 0
	v_mov_b32 v20, 0
	v_mov_b32 v21, 0
	v_mov_b32 v22, 0
	v_mov_b32 v23, 0
	s_waitcnt vmcnt(15)
	v_dot2c_f32_bf16 v16, v64, v128
	v_dot2c_f32_bf16 v17, v64, v129
	v_dot2c_f32_bf16 v18, v65, v128
	v_dot2c_f32_bf16 v19, v65, v129
	v_dot2c_f32_bf16 v20, v66, v128
	v_dot2c_f32_bf16 v21, v66, v129
	v_dot2c_f32_bf16 v22, v67, v128
	v_dot2c_f32_bf16 v23, v67, v129
	s_waitcnt vmcnt(14)
	v_dot2c_f32_bf16 v16, v68, v130
	v_dot2c_f32_bf16 v17, v68, v131
	v_dot2c_f32_bf16 v18, v69, v130
	v_dot2c_f32_bf16 v19, v69, v131
	v_dot2c_f32_bf16 v20, v70, v130
	v_dot2c_f32_bf16 v21, v70, v131
	v_dot2c_f32_bf16 v22, v71, v130
	v_dot2c_f32_bf16 v23, v71, v131
	s_waitcnt vmcnt(13)
	v_dot2c_f32_bf16 v16, v72, v132
	v_dot2c_f32_bf16 v17, v72, v133
	v_dot2c_f32_bf16 v18, v73, v132
	v_dot2c_f32_bf16 v19, v73, v133
	v_dot2c_f32_bf16 v20, v74, v132
	v_dot2c_f32_bf16 v21, v74, v133
	v_dot2c_f32_bf16 v22, v75, v132
	v_dot2c_f32_bf16 v23, v75, v133
	s_waitcnt vmcnt(12)
	v_dot2c_f32_bf16 v16, v76, v134
	v_dot2c_f32_bf16 v17, v76, v135
	v_dot2c_f32_bf16 v18, v77, v134
	v_dot2c_f32_bf16 v19, v77, v135
	v_dot2c_f32_bf16 v20, v78, v134
	v_dot2c_f32_bf16 v21, v78, v135
	v_dot2c_f32_bf16 v22, v79, v134
	v_dot2c_f32_bf16 v23, v79, v135
	s_waitcnt vmcnt(11)
	v_dot2c_f32_bf16 v16, v80, v136
	v_dot2c_f32_bf16 v17, v80, v137
	v_dot2c_f32_bf16 v18, v81, v136
	v_dot2c_f32_bf16 v19, v81, v137
	v_dot2c_f32_bf16 v20, v82, v136
	v_dot2c_f32_bf16 v21, v82, v137
	v_dot2c_f32_bf16 v22, v83, v136
	v_dot2c_f32_bf16 v23, v83, v137
	s_waitcnt vmcnt(10)
	v_dot2c_f32_bf16 v16, v84, v138
	v_dot2c_f32_bf16 v17, v84, v139
	v_dot2c_f32_bf16 v18, v85, v138
	v_dot2c_f32_bf16 v19, v85, v139
	v_dot2c_f32_bf16 v20, v86, v138
	v_dot2c_f32_bf16 v21, v86, v139
	v_dot2c_f32_bf16 v22, v87, v138
	v_dot2c_f32_bf16 v23, v87, v139
	s_waitcnt vmcnt(9)
	v_dot2c_f32_bf16 v16, v88, v140
	v_dot2c_f32_bf16 v17, v88, v141
	v_dot2c_f32_bf16 v18, v89, v140
	v_dot2c_f32_bf16 v19, v89, v141
	v_dot2c_f32_bf16 v20, v90, v140
	v_dot2c_f32_bf16 v21, v90, v141
	v_dot2c_f32_bf16 v22, v91, v140
	v_dot2c_f32_bf16 v23, v91, v141
	s_waitcnt vmcnt(8)
	v_dot2c_f32_bf16 v16, v92, v142
	v_dot2c_f32_bf16 v17, v92, v143
	v_dot2c_f32_bf16 v18, v93, v142
	v_dot2c_f32_bf16 v19, v93, v143
	v_dot2c_f32_bf16 v20, v94, v142
	v_dot2c_f32_bf16 v21, v94, v143
	v_dot2c_f32_bf16 v22, v95, v142
	v_dot2c_f32_bf16 v23, v95, v143
	s_waitcnt vmcnt(7)
	v_dot2c_f32_bf16 v16, v96, v144
	v_dot2c_f32_bf16 v17, v96, v145
	v_dot2c_f32_bf16 v18, v97, v144
	v_dot2c_f32_bf16 v19, v97, v145
	v_dot2c_f32_bf16 v20, v98, v144
	v_dot2c_f32_bf16 v21, v98, v145
	v_dot2c_f32_bf16 v22, v99, v144
	v_dot2c_f32_bf16 v23, v99, v145
	s_waitcnt vmcnt(6)
	v_dot2c_f32_bf16 v16, v100, v146
	v_dot2c_f32_bf16 v17, v100, v147
	v_dot2c_f32_bf16 v18, v101, v146
	v_dot2c_f32_bf16 v19, v101, v147
	v_dot2c_f32_bf16 v20, v102, v146
	v_dot2c_f32_bf16 v21, v102, v147
	v_dot2c_f32_bf16 v22, v103, v146
	v_dot2c_f32_bf16 v23, v103, v147
	s_waitcnt vmcnt(5)
	v_dot2c_f32_bf16 v16, v104, v148
	v_dot2c_f32_bf16 v17, v104, v149
	v_dot2c_f32_bf16 v18, v105, v148
	v_dot2c_f32_bf16 v19, v105, v149
	v_dot2c_f32_bf16 v20, v106, v148
	v_dot2c_f32_bf16 v21, v106, v149
	v_dot2c_f32_bf16 v22, v107, v148
	v_dot2c_f32_bf16 v23, v107, v149
	s_waitcnt vmcnt(4)
	v_dot2c_f32_bf16 v16, v108, v150
	v_dot2c_f32_bf16 v17, v108, v151
	v_dot2c_f32_bf16 v18, v109, v150
	v_dot2c_f32_bf16 v19, v109, v151
	v_dot2c_f32_bf16 v20, v110, v150
	v_dot2c_f32_bf16 v21, v110, v151
	v_dot2c_f32_bf16 v22, v111, v150
	v_dot2c_f32_bf16 v23, v111, v151
	s_waitcnt vmcnt(3)
	v_dot2c_f32_bf16 v16, v112, v152
	v_dot2c_f32_bf16 v17, v112, v153
	v_dot2c_f32_bf16 v18, v113, v152
	v_dot2c_f32_bf16 v19, v113, v153
	v_dot2c_f32_bf16 v20, v114, v152
	v_dot2c_f32_bf16 v21, v114, v153
	v_dot2c_f32_bf16 v22, v115, v152
	v_dot2c_f32_bf16 v23, v115, v153
	s_waitcnt vmcnt(2)
	v_dot2c_f32_bf16 v16, v116, v154
	v_dot2c_f32_bf16 v17, v116, v155
	v_dot2c_f32_bf16 v18, v117, v154
	v_dot2c_f32_bf16 v19, v117, v155
	v_dot2c_f32_bf16 v20, v118, v154
	v_dot2c_f32_bf16 v21, v118, v155
	v_dot2c_f32_bf16 v22, v119, v154
	v_dot2c_f32_bf16 v23, v119, v155
	s_waitcnt vmcnt(1)
	v_dot2c_f32_bf16 v16, v120, v156
	v_dot2c_f32_bf16 v17, v120, v157
	v_dot2c_f32_bf16 v18, v121, v156
	v_dot2c_f32_bf16 v19, v121, v157
	v_dot2c_f32_bf16 v20, v122, v156
	v_dot2c_f32_bf16 v21, v122, v157
	v_dot2c_f32_bf16 v22, v123, v156
	v_dot2c_f32_bf16 v23, v123, v157
	s_waitcnt vmcnt(0)
	v_dot2c_f32_bf16 v16, v124, v158
	v_dot2c_f32_bf16 v17, v124, v159
	v_dot2c_f32_bf16 v18, v125, v158
	v_dot2c_f32_bf16 v19, v125, v159
	v_dot2c_f32_bf16 v20, v126, v158
	v_dot2c_f32_bf16 v21, v126, v159
	v_dot2c_f32_bf16 v22, v127, v158
	v_dot2c_f32_bf16 v23, v127, v159
	v_permlane32_swap_b32 v16, v20
	v_permlane32_swap_b32 v17, v21
	v_permlane32_swap_b32 v18, v22
	v_permlane32_swap_b32 v19, v23
	v_add_f32 v16, v16, v20
	v_add_f32 v17, v17, v21
	v_add_f32 v18, v18, v22
	v_add_f32 v19, v19, v23
	s_nop 0
	v_permlane16_swap_b32 v16, v18
	v_permlane16_swap_b32 v17, v19
	v_add_f32 v24, v16, v18
	v_add_f32 v26, v17, v19
	s_nop 0
	v_add_f32_dpp v24, v24, v24 row_ror:8 row_mask:0xf bank_mask:0xf
	v_add_f32_dpp v26, v26, v26 row_ror:8 row_mask:0xf bank_mask:0xf
	v_mov_b32 v25, s37
	v_mov_b32 v27, s37
	s_lshl_b32 s66, s71, 2
	s_add_u32 s66, s66, s73
	s_mul_i32 s66, s66, 14336
	s_lshl_b32 s67, s72, 9
	s_add_u32 s66, s66, s67
	s_add_u32 s66, s66, 393216
	v_and_b32 v2, 7, v0
	v_lshlrev_b32 v2, 6, v2
	v_lshrrev_b32 v3, 4, v0
	v_lshlrev_b32 v3, 4, v3
	v_add_u32 v2, v2, v3
	s_mov_b32 exec_lo, 0x00ff00ff
	s_mov_b32 exec_hi, 0x00ff00ff
	buffer_store_dwordx4 v[24:27], v2, s[40:43], s66 offen sc1
	s_mov_b64 exec, -1
	s_nop 0
L_Q_end:
	s_mov_b32 s44, s8
	s_mov_b32 s45, s9
	s_mov_b32 s46, 0x400
	s_mov_b32 s47, 0x00020000
	s_mov_b32 s52, s28
	s_mov_b32 s53, s29
	s_mov_b32 s54, 0x400
	s_mov_b32 s55, 0x00020000
	s_waitcnt vmcnt(0)
	v_and_b32 v2, 7, v0
	v_lshlrev_b32 v2, 2, v2
	s_lshl_b32 s66, s35, 5
	v_add_u32 v2, s66, v2
	buffer_load_dword v8, v2, s[44:47], 0 offen
	v_lshlrev_b32 v3, 2, v2
	ds_read_b128 v[12:15], v3 offset:0
	v_mov_b32 v4, 15168
	v_mov_b32 v5, 0
	ds_write_b32 v4, v5
	v_lshrrev_b32 v10, 3, v0
	v_lshlrev_b32 v10, 12, v10
	v_and_b32 v11, 7, v0
	v_lshlrev_b32 v11, 4, v11
	v_add_u32 v10, v10, v11
	s_lshl_b32 s66, s35, 7
	s_add_u32 s66, s66, 65536
	s_xor_b32 s8, s34, 0
	s_lshl_b32 s8, s8, 15
	s_add_u32 s8, s8, s66
	s_xor_b32 s9, s34, 1
	s_lshl_b32 s9, s9, 15
	s_add_u32 s9, s9, s66
	s_xor_b32 s10, s34, 2
	s_lshl_b32 s10, s10, 15
	s_add_u32 s10, s10, s66
	s_xor_b32 s11, s34, 3
	s_lshl_b32 s11, s11, 15
	s_add_u32 s11, s11, s66
	s_xor_b32 s12, s34, 4
	s_lshl_b32 s12, s12, 15
	s_add_u32 s12, s12, s66
	s_xor_b32 s13, s34, 5
	s_lshl_b32 s13, s13, 15
	s_add_u32 s13, s13, s66
	s_xor_b32 s14, s34, 6
	s_lshl_b32 s14, s14, 15
	s_add_u32 s14, s14, s66
	s_xor_b32 s15, s34, 7
	s_lshl_b32 s15, s15, 15
	s_add_u32 s15, s15, s66
	s_mov_b32 s57, 40000
	s_waitcnt vmcnt(0) lgkmcnt(0)
	v_lshlrev_b32 v12, 16, v8
	v_and_b32 v14, s58, v8
	v_add_f32 v12, v12, v13
	v_add_f32 v14, v14, v15
	v_mov_b32 v5, 14852
	s_nop 1
L_Z_w:
	ds_read_b32 v6, v5
	s_waitcnt lgkmcnt(0)
	v_readfirstlane_b32 s66, v6
	s_cmp_ge_u32 s66, 64
	s_nop 2
	s_cbranch_scc1 L_Z_wd
	s_sub_u32 s57, s57, 1
	s_cmp_eq_u32 s57, 0
	s_cbranch_scc1 L_Z_wd
	s_sleep 8
	s_branch L_Z_w
L_Z_wd:
	s_add_u32 s66, s8, 720896
	buffer_load_dwordx4 v[100:103], v10, s[40:43], s66 offen sc1
	s_mov_b32 s57, 40000
	v_mov_b32 v5, 14856
	s_barrier
	ds_read_b32 v6, v5
	s_waitcnt lgkmcnt(0)
	v_readfirstlane_b32 s66, v6
	s_cmp_eq_u32 s66, 0
	s_cselect_b32 s66, 0, 720896
	s_add_u32 s8, s8, s66
	s_barrier
	s_nop 0
L_Z_tk:
	ds_read_b32 v6, v4
	s_waitcnt lgkmcnt(0)
	v_readfirstlane_b32 s71, v6
	s_cmp_lg_u32 s71, 0
	s_nop 2
	s_cbranch_scc1 L_Z_tkd
	s_sub_u32 s57, s57, 1
	s_cmp_eq_u32 s57, 0
	s_cbranch_scc1 L_Z_tkd
	s_branch L_Z_tk
L_Z_tkd:
	s_cmp_ge_u32 s71, 1
	s_cselect_b32 s70, s71, 8
	s_cmp_eq_u32 s70, 8
	s_cbranch_scc0 L_Z_out
	s_mov_b32 s57, 40000
	buffer_load_dwordx4 v[68:71], v10, s[40:43], s9 offen sc1
	buffer_load_dwordx4 v[72:75], v10, s[40:43], s10 offen sc1
	buffer_load_dwordx4 v[76:79], v10, s[40:43], s11 offen sc1
	buffer_load_dwordx4 v[80:83], v10, s[40:43], s12 offen sc1
	buffer_load_dwordx4 v[84:87], v10, s[40:43], s13 offen sc1
	buffer_load_dwordx4 v[88:91], v10, s[40:43], s14 offen sc1
	buffer_load_dwordx4 v[92:95], v10, s[40:43], s15 offen sc1
	s_sleep 8
	buffer_load_dwordx4 v[64:67], v10, s[40:43], s8 offen sc1
	s_sleep 4
	buffer_load_dwordx4 v[100:103], v10, s[40:43], s8 offen sc1
	s_sleep 4
	buffer_load_dwordx4 v[104:107], v10, s[40:43], s8 offen sc1
	s_sleep 4
	buffer_load_dwordx4 v[108:111], v10, s[40:43], s8 offen sc1
	s_waitcnt vmcnt(4)
	v_xor_b32 v30, s37, v69
	v_xor_b32 v31, s37, v71
	v_or_b32 v30, v30, v31
	v_xor_b32 v31, s37, v73
	v_or_b32 v30, v30, v31
	v_xor_b32 v31, s37, v75
	v_or_b32 v30, v30, v31
	v_xor_b32 v31, s37, v77
	v_or_b32 v30, v30, v31
	v_xor_b32 v31, s37, v79
	v_or_b32 v30, v30, v31
	v_xor_b32 v31, s37, v81
	v_or_b32 v30, v30, v31
	v_xor_b32 v31, s37, v83
	v_or_b32 v30, v30, v31
	v_xor_b32 v31, s37, v85
	v_or_b32 v30, v30, v31
	v_xor_b32 v31, s37, v87
	v_or_b32 v30, v30, v31
	v_xor_b32 v31, s37, v89
	v_or_b32 v30, v30, v31
	v_xor_b32 v31, s37, v91
	v_or_b32 v30, v30, v31
	v_xor_b32 v31, s37, v93
	v_or_b32 v30, v30, v31
	v_xor_b32 v31, s37, v95
	v_or_b32 v30, v30, v31
	v_cmp_ne_u32 vcc, 0, v30
	s_nop 3
	s_cbranch_vccnz L_Z_slow
L_Z_fast:
	s_waitcnt vmcnt(3)
	v_xor_b32 v30, s37, v65
	v_xor_b32 v31, s37, v67
	v_or_b32 v30, v30, v31
	v_cmp_ne_u32 vcc, 0, v30
	s_nop 3
	s_cbranch_vccz L_Z_f0
	buffer_load_dwordx4 v[64:67], v10, s[40:43], s8 offen sc1
	s_waitcnt vmcnt(3)
	v_xor_b32 v30, s37, v101
	v_xor_b32 v31, s37, v103
	v_or_b32 v30, v30, v31
	v_cmp_ne_u32 vcc, 0, v30
	s_nop 3
	s_cbranch_vccz L_Z_f1
	buffer_load_dwordx4 v[100:103], v10, s[40:43], s8 offen sc1
	s_waitcnt vmcnt(3)
	v_xor_b32 v30, s37, v105
	v_xor_b32 v31, s37, v107
	v_or_b32 v30, v30, v31
	v_cmp_ne_u32 vcc, 0, v30
	s_nop 3
	s_cbranch_vccz L_Z_f2
	buffer_load_dwordx4 v[104:107], v10, s[40:43], s8 offen sc1
	s_waitcnt vmcnt(3)
	v_xor_b32 v30, s37, v109
	v_xor_b32 v31, s37, v111
	v_or_b32 v30, v30, v31
	v_cmp_ne_u32 vcc, 0, v30
	s_nop 3
	s_cbranch_vccz L_Z_f3
	buffer_load_dwordx4 v[108:111], v10, s[40:43], s8 offen sc1
	s_sub_u32 s57, s57, 1
	s_cmp_eq_u32 s57, 0
	s_cbranch_scc1 L_Z_f0
	s_branch L_Z_fast
L_Z_f3:
	v_add_f32 v20, v108, v68
	v_add_f32 v22, v110, v70
	s_nop 0
	s_branch L_Z_sum
L_Z_f2:
	v_add_f32 v20, v104, v68
	v_add_f32 v22, v106, v70
	s_nop 0
	s_branch L_Z_sum
L_Z_f1:
	v_add_f32 v20, v100, v68
	v_add_f32 v22, v102, v70
	s_nop 0
	s_branch L_Z_sum
L_Z_slow:
	buffer_load_dwordx4 v[112:115], v10, s[40:43], s8 offen sc1
	buffer_load_dwordx4 v[116:119], v10, s[40:43], s9 offen sc1
	buffer_load_dwordx4 v[120:123], v10, s[40:43], s10 offen sc1
	buffer_load_dwordx4 v[124:127], v10, s[40:43], s11 offen sc1
	buffer_load_dwordx4 v[128:131], v10, s[40:43], s12 offen sc1
	buffer_load_dwordx4 v[132:135], v10, s[40:43], s13 offen sc1
	buffer_load_dwordx4 v[136:139], v10, s[40:43], s14 offen sc1
	buffer_load_dwordx4 v[140:143], v10, s[40:43], s15 offen sc1
	s_sleep 10
	buffer_load_dwordx4 v[64:67], v10, s[40:43], s8 offen sc1
	buffer_load_dwordx4 v[68:71], v10, s[40:43], s9 offen sc1
	buffer_load_dwordx4 v[72:75], v10, s[40:43], s10 offen sc1
	buffer_load_dwordx4 v[76:79], v10, s[40:43], s11 offen sc1
	buffer_load_dwordx4 v[80:83], v10, s[40:43], s12 offen sc1
	buffer_load_dwordx4 v[84:87], v10, s[40:43], s13 offen sc1
	buffer_load_dwordx4 v[88:91], v10, s[40:43], s14 offen sc1
	buffer_load_dwordx4 v[92:95], v10, s[40:43], s15 offen sc1
L_Z_sl:
	s_waitcnt vmcnt(8)
	v_xor_b32 v29, s37, v113
	v_xor_b32 v31, s37, v115
	v_or_b32 v29, v29, v31
	v_xor_b32 v31, s37, v117
	v_or_b32 v29, v29, v31
	v_xor_b32 v31, s37, v119
	v_or_b32 v29, v29, v31
	v_xor_b32 v31, s37, v121
	v_or_b32 v29, v29, v31
	v_xor_b32 v31, s37, v123
	v_or_b32 v29, v29, v31
	v_xor_b32 v31, s37, v125
	v_or_b32 v29, v29, v31
	v_xor_b32 v31, s37, v127
	v_or_b32 v29, v29, v31
	v_xor_b32 v31, s37, v129
	v_or_b32 v29, v29, v31
	v_xor_b32 v31, s37, v131
	v_or_b32 v29, v29, v31
	v_xor_b32 v31, s37, v133
	v_or_b32 v29, v29, v31
	v_xor_b32 v31, s37, v135
	v_or_b32 v29, v29, v31
	v_xor_b32 v31, s37, v137
	v_or_b32 v29, v29, v31
	v_xor_b32 v31, s37, v139
	v_or_b32 v29, v29, v31
	v_xor_b32 v31, s37, v141
	v_or_b32 v29, v29, v31
	v_xor_b32 v31, s37, v143
	v_or_b32 v29, v29, v31
	v_cmp_ne_u32 vcc, 0, v29
	s_nop 3
	s_cbranch_vccz L_Z_b1
	buffer_load_dwordx4 v[112:115], v10, s[40:43], s8 offen sc1
	buffer_load_dwordx4 v[116:119], v10, s[40:43], s9 offen sc1
	buffer_load_dwordx4 v[120:123], v10, s[40:43], s10 offen sc1
	buffer_load_dwordx4 v[124:127], v10, s[40:43], s11 offen sc1
	buffer_load_dwordx4 v[128:131], v10, s[40:43], s12 offen sc1
	buffer_load_dwordx4 v[132:135], v10, s[40:43], s13 offen sc1
	buffer_load_dwordx4 v[136:139], v10, s[40:43], s14 offen sc1
	buffer_load_dwordx4 v[140:143], v10, s[40:43], s15 offen sc1
	s_waitcnt vmcnt(8)
	v_xor_b32 v29, s37, v65
	v_xor_b32 v31, s37, v67
	v_or_b32 v29, v29, v31
	v_xor_b32 v31, s37, v69
	v_or_b32 v29, v29, v31
	v_xor_b32 v31, s37, v71
	v_or_b32 v29, v29, v31
	v_xor_b32 v31, s37, v73
	v_or_b32 v29, v29, v31
	v_xor_b32 v31, s37, v75
	v_or_b32 v29, v29, v31
	v_xor_b32 v31, s37, v77
	v_or_b32 v29, v29, v31
	v_xor_b32 v31, s37, v79
	v_or_b32 v29, v29, v31
	v_xor_b32 v31, s37, v81
	v_or_b32 v29, v29, v31
	v_xor_b32 v31, s37, v83
	v_or_b32 v29, v29, v31
	v_xor_b32 v31, s37, v85
	v_or_b32 v29, v29, v31
	v_xor_b32 v31, s37, v87
	v_or_b32 v29, v29, v31
	v_xor_b32 v31, s37, v89
	v_or_b32 v29, v29, v31
	v_xor_b32 v31, s37, v91
	v_or_b32 v29, v29, v31
	v_xor_b32 v31, s37, v93
	v_or_b32 v29, v29, v31
	v_xor_b32 v31, s37, v95
	v_or_b32 v29, v29, v31
	v_cmp_ne_u32 vcc, 0, v29
	s_nop 3
	s_cbranch_vccz L_Z_b0
	buffer_load_dwordx4 v[64:67], v10, s[40:43], s8 offen sc1
	buffer_load_dwordx4 v[68:71], v10, s[40:43], s9 offen sc1
	buffer_load_dwordx4 v[72:75], v10, s[40:43], s10 offen sc1
	buffer_load_dwordx4 v[76:79], v10, s[40:43], s11 offen sc1
	buffer_load_dwordx4 v[80:83], v10, s[40:43], s12 offen sc1
	buffer_load_dwordx4 v[84:87], v10, s[40:43], s13 offen sc1
	buffer_load_dwordx4 v[88:91], v10, s[40:43], s14 offen sc1
	buffer_load_dwordx4 v[92:95], v10, s[40:43], s15 offen sc1
	s_sub_u32 s57, s57, 1
	s_cmp_eq_u32 s57, 0
	s_cbranch_scc1 L_Z_b0
	s_branch L_Z_sl
L_Z_b1:
	v_add_f32 v20, v112, v116
	v_add_f32 v24, v120, v124
	v_add_f32 v28, v128, v132
	v_add_f32 v32, v136, v140
	v_add_f32 v22, v114, v118
	v_add_f32 v26, v122, v126
	v_add_f32 v30, v130, v134
	v_add_f32 v34, v138, v142
	s_nop 0
	s_branch L_Z_l2
L_Z_b0:
L_Z_f0:
	v_add_f32 v20, v64, v68
	v_add_f32 v22, v66, v70
	s_nop 1
L_Z_sum:
	v_add_f32 v24, v72, v76
	v_add_f32 v28, v80, v84
	v_add_f32 v32, v88, v92
	v_add_f32 v26, v74, v78
	v_add_f32 v30, v82, v86
	v_add_f32 v34, v90, v94
	s_nop 1
L_Z_l2:
	v_add_f32 v20, v20, v24
	v_add_f32 v28, v28, v32
	v_add_f32 v22, v22, v26
	v_add_f32 v30, v30, v34
	v_add_f32 v20, v20, v28
	v_add_f32 v22, v22, v30
	s_nop 0
	v_add_f32_dpp v20, v20, v20 row_ror:8 row_mask:0xf bank_mask:0xf
	v_add_f32_dpp v22, v22, v22 row_ror:8 row_mask:0xf bank_mask:0xf
	v_mov_b32 v30, v20
	s_nop 1
	v_permlane16_swap_b32 v20, v30
	v_add_f32 v20, v20, v30
	v_mov_b32 v30, v20
	s_nop 1
	v_permlane32_swap_b32 v20, v30
	v_add_f32 v20, v20, v30
	v_mov_b32 v31, v22
	s_nop 1
	v_permlane16_swap_b32 v22, v31
	v_add_f32 v22, v22, v31
	v_mov_b32 v31, v22
	s_nop 1
	v_permlane32_swap_b32 v22, v31
	v_add_f32 v22, v22, v31
	v_add_f32 v24, v20, v12
	v_add_f32 v26, v22, v14
	v_cvt_pk_bf16_f32 v24, v24, v26
	s_mov_b64 exec, 0xff
	buffer_store_dword v24, v2, s[52:55], 0 offen
	s_cmp_lg_u32 s35, 0
	s_cbranch_scc1 L_Z_noep
	s_mov_b64 exec, 1
	v_mov_b32 v25, s37
	v_mov_b32 v26, 0
	buffer_store_dword v25, v26, s[40:43], 0 offen sc1
	s_nop 0
L_Z_noep:
	s_mov_b64 exec, -1
L_Z_out:
	s_waitcnt vmcnt(0)
	s_branch L_end
L_W:
	s_lshr_b32 s76, s35, 2
	s_and_b32 s77, s35, 3
	s_lshl_b32 s78, s34, 3
	s_add_u32 s78, s78, s76
	s_lshl_b32 s66, s78, 16
	s_lshl_b32 s67, s77, 8
	s_add_u32 s66, s66, s67
	s_add_u32 s44, s16, s66
	s_addc_u32 s45, s17, 0
	s_mov_b32 s46, 0x10000
	s_mov_b32 s47, 0x00020000
	s_sub_u32 s46, 65536, s67
	s_mul_i32 s66, s78, 28672
	s_add_u32 s66, s66, s67
	s_add_u32 s4, s26, s66
	s_addc_u32 s5, s27, 0
	s_mov_b32 s6, 0x7000
	s_mov_b32 s7, 0x00020000
	s_sub_u32 s6, 28672, s67
	s_mov_b32 s48, s8
	s_mov_b32 s49, s9
	s_mov_b32 s50, 0x400
	s_mov_b32 s51, 0x00020000
	s_mov_b32 s52, s28
	s_mov_b32 s53, s29
	s_mov_b32 s54, 0x400
	s_mov_b32 s55, 0x00020000
	v_lshrrev_b32 v1, 4, v0
	v_lshlrev_b32 v1, 10, v1
	v_and_b32 v2, 15, v0
	v_lshlrev_b32 v2, 4, v2
	v_add_u32 v1, v1, v2
	s_getreg_b32 s75, hwreg(HW_REG_XCC_ID)
	s_lshl_b32 s74, s34, 8
	s_add_u32 s74, s74, 24576
	s_lshl_b32 s66, s35, 3
	v_mov_b32 v16, s75
	v_mov_b32 v17, s37
	v_mov_b32 v18, s66
	s_mov_b64 exec, 1
	buffer_store_dwordx2 v[16:17], v18, s[40:43], s74 offen sc1
	s_mov_b64 exec, -1
	s_barrier
	s_setprio 3
	s_mov_b32 s56, 0
	buffer_load_dwordx4 v[64:67], v1, s[44:47], s56 offen nt
	s_add_u32 s56, s56, 4096
	buffer_load_dwordx4 v[68:71], v1, s[44:47], s56 offen nt
	s_add_u32 s56, s56, 4096
	buffer_load_dwordx4 v[72:75], v1, s[44:47], s56 offen nt
	s_add_u32 s56, s56, 4096
	buffer_load_dwordx4 v[76:79], v1, s[44:47], s56 offen nt
	s_add_u32 s56, s56, 4096
	buffer_load_dwordx4 v[80:83], v1, s[44:47], s56 offen nt
	s_add_u32 s56, s56, 4096
	buffer_load_dwordx4 v[84:87], v1, s[44:47], s56 offen nt
	s_add_u32 s56, s56, 4096
	buffer_load_dwordx4 v[88:91], v1, s[44:47], s56 offen nt
	s_add_u32 s56, s56, 4096
	buffer_load_dwordx4 v[92:95], v1, s[44:47], s56 offen nt
	s_add_u32 s56, s56, 4096
	buffer_load_dwordx4 v[96:99], v1, s[44:47], s56 offen nt
	s_add_u32 s56, s56, 4096
	buffer_load_dwordx4 v[100:103], v1, s[44:47], s56 offen nt
	s_add_u32 s56, s56, 4096
	buffer_load_dwordx4 v[104:107], v1, s[44:47], s56 offen nt
	s_add_u32 s56, s56, 4096
	buffer_load_dwordx4 v[108:111], v1, s[44:47], s56 offen nt
	s_add_u32 s56, s56, 4096
	buffer_load_dwordx4 v[112:115], v1, s[44:47], s56 offen nt
	s_add_u32 s56, s56, 4096
	buffer_load_dwordx4 v[116:119], v1, s[44:47], s56 offen nt
	s_add_u32 s56, s56, 4096
	buffer_load_dwordx4 v[120:123], v1, s[44:47], s56 offen nt
	s_add_u32 s56, s56, 4096
	buffer_load_dwordx4 v[124:127], v1, s[44:47], s56 offen nt
	s_mov_b32 s56, 0
	buffer_load_dwordx4 v[128:131], v1, s[4:7], s56 offen nt
	s_add_u32 s56, s56, 4096
	buffer_load_dwordx4 v[132:135], v1, s[4:7], s56 offen nt
	s_add_u32 s56, s56, 4096
	buffer_load_dwordx4 v[136:139], v1, s[4:7], s56 offen nt
	s_add_u32 s56, s56, 4096
	buffer_load_dwordx4 v[140:143], v1, s[4:7], s56 offen nt
	s_add_u32 s56, s56, 4096
	buffer_load_dwordx4 v[144:147], v1, s[4:7], s56 offen nt
	s_add_u32 s56, s56, 4096
	buffer_load_dwordx4 v[148:151], v1, s[4:7], s56 offen nt
	s_add_u32 s56, s56, 4096
	buffer_load_dwordx4 v[152:155], v1, s[4:7], s56 offen nt
	s_lshl_b32 s68, s34, 7
	s_lshl_b32 s69, s35, 2
	s_add_u32 s68, s68, s69
	v_mov_b32 v2, s68
	buffer_load_dword v8, v2, s[48:51], 0 offen
	s_lshl_b32 s69, s68, 2
	v_mov_b32 v3, s69
	ds_read_b128 v[12:15], v3 offset:0
	v_mov_b32 v3, 14848
	ds_read_b32 v9, v3
	v_and_b32 v28, 3, v0
	v_mov_b32 v5, 0
	v_mov_b32 v7, 0
	v_mov_b32 v29, 0xffff
	v_mov_b32 v30, s58
	v_cmp_eq_u32 vcc, 0, v28
	s_nop 1
	v_cndmask_b32 v5, v5, v29, vcc
	v_cmp_eq_u32 vcc, 1, v28
	s_nop 1
	v_cndmask_b32 v5, v5, v30, vcc
	v_cmp_eq_u32 vcc, 2, v28
	s_nop 1
	v_cndmask_b32 v7, v7, v29, vcc
	v_cmp_eq_u32 vcc, 3, v28
	s_nop 1
	v_cndmask_b32 v7, v7, v30, vcc
	v_mov_b32 v32, 0
	v_mov_b32 v33, 0
	v_mov_b32 v36, 0
	v_mov_b32 v37, 0
	v_mov_b32 v40, 0
	v_mov_b32 v41, 0
	v_mov_b32 v44, 0
	v_mov_b32 v45, 0
	v_mov_b32 v48, 0
	v_mov_b32 v49, 0
	v_mov_b32 v56, 0
	v_mov_b32 v57, 0
	v_mov_b32 v58, 0
	v_mov_b32 v59, 0
	v_mov_b32 v60, 0
	v_mov_b32 v61, 0
	v_mov_b32 v62, 0
	v_mov_b32 v63, 0
	s_mov_b32 s62, 0xffff0000
	s_mov_b32 s63, 0xffff0000
	s_mov_b32 s64, 0
	s_mov_b32 s65, -1
	s_mul_i32 s70, s78, 224
	s_add_u32 s70, s70, 393216
	s_add_u32 s71, s70, 57344
	v_lshrrev_b32 v10, 4, v0
	s_mov_b32 s66, 14336
	v_mul_lo_u32 v10, v10, s66
	v_and_b32 v11, 15, v0
	v_min_u32 v11, 13, v11
	v_lshlrev_b32 v11, 4, v11
	v_add_u32 v10, v10, v11
	v_and_b32 v11, 31, v0
	v_lshlrev_b32 v11, 3, v11
	s_nop 1
L_W_ypoll:
	buffer_load_dwordx4 v[16:19], v10, s[40:43], s70 offen sc1
	buffer_load_dwordx4 v[20:23], v10, s[40:43], s71 offen sc1
	buffer_load_dwordx2 v[24:25], v11, s[40:43], s74 offen sc1
	s_waitcnt vmcnt(0)
	v_xor_b32 v30, s37, v17
	v_xor_b32 v31, s37, v19
	v_or_b32 v30, v30, v31
	v_xor_b32 v31, s37, v21
	v_or_b32 v30, v30, v31
	v_xor_b32 v31, s37, v23
	v_or_b32 v30, v30, v31
	v_xor_b32 v31, s37, v25
	v_or_b32 v30, v30, v31
	v_cmp_ne_u32 vcc, 0, v30
	s_nop 3
	s_cbranch_vccz L_W_ygot
	s_sub_u32 s57, s57, 1
	s_cmp_eq_u32 s57, 0
	s_cbranch_scc1 L_W_ygot
	s_sleep 32
	s_branch L_W_ypoll
L_W_ygot:
	v_cmp_ne_u32 vcc, s75, v24
	s_cmp_eq_u64 vcc, 0
	s_cselect_b32 s66, 1, 0
	v_mov_b32 v26, s66
	v_mov_b32 v27, 14856
	ds_write_b32 v27, v26
	s_mov_b32 s79, s66
	v_mov_b32 v30, v16
	s_nop 1
	v_permlane16_swap_b32 v16, v30
	v_add_f32 v16, v16, v30
	v_mov_b32 v30, v16
	s_nop 1
	v_permlane32_swap_b32 v16, v30
	v_add_f32 v16, v16, v30
	v_mov_b32 v30, v18
	s_nop 1
	v_permlane16_swap_b32 v18, v30
	v_add_f32 v18, v18, v30
	v_mov_b32 v30, v18
	s_nop 1
	v_permlane32_swap_b32 v18, v30
	v_add_f32 v18, v18, v30
	v_mov_b32 v30, v20
	s_nop 1
	v_permlane16_swap_b32 v20, v30
	v_add_f32 v20, v20, v30
	v_mov_b32 v30, v20
	s_nop 1
	v_permlane32_swap_b32 v20, v30
	v_add_f32 v20, v20, v30
	v_mov_b32 v30, v22
	s_nop 1
	v_permlane16_swap_b32 v22, v30
	v_add_f32 v22, v22, v30
	v_mov_b32 v30, v22
	s_nop 1
	v_permlane32_swap_b32 v22, v30
	v_add_f32 v22, v22, v30
	v_cvt_pk_bf16_f32 v16, v16, v16
	v_and_b32 v16, s58, v16
	v_cvt_pk_bf16_f32 v18, v18, v18
	v_and_b32 v18, s58, v18
	v_cvt_pk_bf16_f32 v20, v20, v20
	v_and_b32 v20, s58, v20
	v_cvt_pk_bf16_f32 v22, v22, v22
	v_and_b32 v22, s58, v22
	v_mul_f32 v28, s59, v16
	v_sub_f32 v28, 0, v28
	v_exp_f32 v28, v28
	s_nop 0
	v_add_f32 v28, 1.0, v28
	v_rcp_f32 v28, v28
	s_nop 0
	v_mul_f32 v16, v16, v28
	v_cvt_pk_bf16_f32 v16, v16, v16
	v_and_b32 v16, s58, v16
	v_mul_f32 v28, s59, v18
	v_sub_f32 v28, 0, v28
	v_exp_f32 v28, v28
	s_nop 0
	v_add_f32 v28, 1.0, v28
	v_rcp_f32 v28, v28
	s_nop 0
	v_mul_f32 v18, v18, v28
	v_cvt_pk_bf16_f32 v18, v18, v18
	v_and_b32 v18, s58, v18
	v_mul_f32 v16, v16, v20
	v_mul_f32 v18, v18, v22
	v_cvt_pk_bf16_f32 v16, v16, v16
	v_cvt_pk_bf16_f32 v18, v18, v18
	v_and_b32 v20, 1, v0
	v_lshlrev_b32 v20, 7, v20
	v_bfe_u32 v21, v0, 1, 3
	v_lshlrev_b32 v21, 2, v21
	v_add_u32 v20, v20, v21
	s_mov_b64 exec, 0x3fff
	ds_write_b32 v20, v16 offset:14912
	ds_write_b32 v20, v18 offset:14976
	s_mov_b64 exec, -1
	v_lshrrev_b32 v24, 4, v0
	v_lshlrev_b32 v24, 6, v24
	s_waitcnt lgkmcnt(0)
	ds_read_b128 v[160:163], v24 offset:14912
	ds_read_b128 v[164:167], v24 offset:14928
	s_waitcnt lgkmcnt(0)
	v_and_b32 v34, v160, v5
	v_and_b32 v35, v160, v7
	v_and_b32 v38, v161, v5
	v_and_b32 v39, v161, v7
	v_and_b32 v42, v162, v5
	v_and_b32 v43, v162, v7
	v_and_b32 v46, v163, v5
	v_and_b32 v47, v163, v7
	v_mfma_f32_16x16x32_bf16 v[56:59], v[34:37], v[128:131], v[56:59]
	v_mfma_f32_16x16x32_bf16 v[60:63], v[32:35], v[128:131], v[60:63]
	v_mfma_f32_16x16x32_bf16 v[56:59], v[38:41], v[132:135], v[56:59]
	v_mfma_f32_16x16x32_bf16 v[60:63], v[36:39], v[132:135], v[60:63]
	v_mfma_f32_16x16x32_bf16 v[56:59], v[42:45], v[136:139], v[56:59]
	v_mfma_f32_16x16x32_bf16 v[60:63], v[40:43], v[136:139], v[60:63]
	v_mfma_f32_16x16x32_bf16 v[56:59], v[46:49], v[140:143], v[56:59]
	v_mfma_f32_16x16x32_bf16 v[60:63], v[44:47], v[140:143], v[60:63]
	v_and_b32 v34, v164, v5
	v_and_b32 v35, v164, v7
	v_and_b32 v38, v165, v5
	v_and_b32 v39, v165, v7
	v_and_b32 v42, v166, v5
	v_and_b32 v43, v166, v7
	v_mfma_f32_16x16x32_bf16 v[56:59], v[34:37], v[144:147], v[56:59]
	v_mfma_f32_16x16x32_bf16 v[60:63], v[32:35], v[144:147], v[60:63]
	v_mfma_f32_16x16x32_bf16 v[56:59], v[38:41], v[148:151], v[56:59]
	v_mfma_f32_16x16x32_bf16 v[60:63], v[36:39], v[148:151], v[60:63]
	v_mfma_f32_16x16x32_bf16 v[56:59], v[42:45], v[152:155], v[56:59]
	v_mfma_f32_16x16x32_bf16 v[60:63], v[40:43], v[152:155], v[60:63]
	s_nop 6
	v_mul_f32 v56, v56, v9
	v_mul_f32 v57, v57, v9
	v_mul_f32 v58, v58, v9
	v_mul_f32 v59, v59, v9
	v_mul_f32 v60, v60, v9
	v_mul_f32 v61, v61, v9
	v_mul_f32 v62, v62, v9
	v_mul_f32 v63, v63, v9
	v_lshlrev_b32 v12, 16, v8
	v_and_b32 v14, s58, v8
	v_add_f32 v12, v12, v13
	v_add_f32 v14, v14, v15
	s_lshl_b32 s72, s78, 12
	s_lshl_b32 s73, s77, 10
	s_add_u32 s72, s72, s73
	s_add_u32 s72, s72, 65536
	v_and_b32 v20, 15, v0
	v_lshlrev_b32 v20, 6, v20
	v_lshrrev_b32 v21, 4, v0
	v_lshlrev_b32 v21, 4, v21
	v_add_u32 v20, v20, v21
	s_lshl_b32 s73, s68, 2
	s_add_u32 s73, s73, 65536
	s_add_u32 s73, s72, 720896
	v_lshlrev_b32 v10, 12, v0
	v_lshlrev_b32 v22, 2, v0
	v_and_b32 v23, 3, v0
	v_lshlrev_b32 v23, 6, v23
	v_lshrrev_b32 v25, 2, v0
	v_lshlrev_b32 v25, 2, v25
	v_add_u32 v23, v23, v25
	v_mov_b32 v29, s37
	v_mov_b32 v31, s37
	s_mov_b32 s57, 40000
	s_waitcnt lgkmcnt(0)
	s_barrier
	s_barrier
	ds_read_b32 v16, v22 offset:13568
	ds_read_b32 v17, v22 offset:13824
	ds_read_b32 v18, v22 offset:14080
	ds_read_b32 v19, v22 offset:14336
	s_waitcnt lgkmcnt(0)
	v_add_f32 v16, v16, v17
	v_add_f32 v18, v18, v19
	v_add_f32 v26, v16, v18
	v_cvt_pk_bf16_f32 v26, v26, v26
	ds_write_b32 v23, v26 offset:14592
	s_waitcnt lgkmcnt(0)
	ds_read_b128 v[168:171], v24 offset:14592
	ds_read_b128 v[172:175], v24 offset:14608
	ds_read_b128 v[176:179], v24 offset:14624
	ds_read_b128 v[180:183], v24 offset:14640
	s_waitcnt lgkmcnt(0)
	v_and_b32 v34, v168, v5
	v_and_b32 v35, v168, v7
	v_and_b32 v38, v169, v5
	v_and_b32 v39, v169, v7
	v_and_b32 v42, v170, v5
	v_and_b32 v43, v170, v7
	v_and_b32 v46, v171, v5
	v_and_b32 v47, v171, v7
	v_mfma_f32_16x16x32_bf16 v[56:59], v[34:37], v[64:67], v[56:59]
	v_mfma_f32_16x16x32_bf16 v[60:63], v[32:35], v[64:67], v[60:63]
	v_mfma_f32_16x16x32_bf16 v[56:59], v[38:41], v[68:71], v[56:59]
	v_mfma_f32_16x16x32_bf16 v[60:63], v[36:39], v[68:71], v[60:63]
	v_mfma_f32_16x16x32_bf16 v[56:59], v[42:45], v[72:75], v[56:59]
	v_mfma_f32_16x16x32_bf16 v[60:63], v[40:43], v[72:75], v[60:63]
	v_mfma_f32_16x16x32_bf16 v[56:59], v[46:49], v[76:79], v[56:59]
	v_mfma_f32_16x16x32_bf16 v[60:63], v[44:47], v[76:79], v[60:63]
	v_and_b32 v34, v172, v5
	v_and_b32 v35, v172, v7
	v_and_b32 v38, v173, v5
	v_and_b32 v39, v173, v7
	v_and_b32 v42, v174, v5
	v_and_b32 v43, v174, v7
	v_and_b32 v46, v175, v5
	v_and_b32 v47, v175, v7
	v_mfma_f32_16x16x32_bf16 v[56:59], v[34:37], v[80:83], v[56:59]
	v_mfma_f32_16x16x32_bf16 v[60:63], v[32:35], v[80:83], v[60:63]
	v_mfma_f32_16x16x32_bf16 v[56:59], v[38:41], v[84:87], v[56:59]
	v_mfma_f32_16x16x32_bf16 v[60:63], v[36:39], v[84:87], v[60:63]
	v_mfma_f32_16x16x32_bf16 v[56:59], v[42:45], v[88:91], v[56:59]
	v_mfma_f32_16x16x32_bf16 v[60:63], v[40:43], v[88:91], v[60:63]
	v_mfma_f32_16x16x32_bf16 v[56:59], v[46:49], v[92:95], v[56:59]
	v_mfma_f32_16x16x32_bf16 v[60:63], v[44:47], v[92:95], v[60:63]
	v_and_b32 v34, v176, v5
	v_and_b32 v35, v176, v7
	v_and_b32 v38, v177, v5
	v_and_b32 v39, v177, v7
	v_and_b32 v42, v178, v5
	v_and_b32 v43, v178, v7
	v_and_b32 v46, v179, v5
	v_and_b32 v47, v179, v7
	v_mfma_f32_16x16x32_bf16 v[56:59], v[34:37], v[96:99], v[56:59]
	v_mfma_f32_16x16x32_bf16 v[60:63], v[32:35], v[96:99], v[60:63]
	v_mfma_f32_16x16x32_bf16 v[56:59], v[38:41], v[100:103], v[56:59]
	v_mfma_f32_16x16x32_bf16 v[60:63], v[36:39], v[100:103], v[60:63]
	v_mfma_f32_16x16x32_bf16 v[56:59], v[42:45], v[104:107], v[56:59]
	v_mfma_f32_16x16x32_bf16 v[60:63], v[40:43], v[104:107], v[60:63]
	v_mfma_f32_16x16x32_bf16 v[56:59], v[46:49], v[108:111], v[56:59]
	v_mfma_f32_16x16x32_bf16 v[60:63], v[44:47], v[108:111], v[60:63]
	v_and_b32 v34, v180, v5
	v_and_b32 v35, v180, v7
	v_and_b32 v38, v181, v5
	v_and_b32 v39, v181, v7
	v_and_b32 v42, v182, v5
	v_and_b32 v43, v182, v7
	v_and_b32 v46, v183, v5
	v_and_b32 v47, v183, v7
	v_mfma_f32_16x16x32_bf16 v[56:59], v[34:37], v[112:115], v[56:59]
	v_mfma_f32_16x16x32_bf16 v[60:63], v[32:35], v[112:115], v[60:63]
	v_mfma_f32_16x16x32_bf16 v[56:59], v[38:41], v[116:119], v[56:59]
	v_mfma_f32_16x16x32_bf16 v[60:63], v[36:39], v[116:119], v[60:63]
	v_mfma_f32_16x16x32_bf16 v[56:59], v[42:45], v[120:123], v[56:59]
	v_mfma_f32_16x16x32_bf16 v[60:63], v[40:43], v[120:123], v[60:63]
	v_mfma_f32_16x16x32_bf16 v[56:59], v[46:49], v[124:127], v[56:59]
	v_mfma_f32_16x16x32_bf16 v[60:63], v[44:47], v[124:127], v[60:63]
	s_nop 6
	v_cndmask_b32 v26, v56, v58, s[62:63]
	v_cndmask_b32 v27, v60, v62, s[62:63]
	v_cndmask_b32 v28, v26, v27, s[64:65]
	v_cndmask_b32 v26, v57, v59, s[62:63]
	v_cndmask_b32 v27, v61, v63, s[62:63]
	v_cndmask_b32 v30, v26, v27, s[64:65]
	s_cmp_eq_u32 s79, 0
	s_cbranch_scc1 L_W_nl
	buffer_store_dwordx4 v[28:31], v20, s[40:43], s73 offen
	s_nop 1
L_W_nl:
	buffer_store_dwordx4 v[28:31], v20, s[40:43], s72 offen sc1
	s_nop 0
	s_branch L_end
L_end:
	s_endpgm

.section .rodata,"a"
.p2align 6
.amdhsa_kernel parallel_sum__gqa_block_cached__moe_arch_mod__decode_kernel
  .amdhsa_next_free_vgpr 256
  .amdhsa_next_free_sgpr 102
  .amdhsa_accum_offset 256
  .amdhsa_group_segment_fixed_size 0
  .amdhsa_kernarg_size 104
  .amdhsa_user_sgpr_count 2
  .amdhsa_user_sgpr_kernarg_segment_ptr 1
  .amdhsa_system_sgpr_workgroup_id_x 1
.end_amdhsa_kernel
```
